```python
import torch

def _softmax(x, axis=-1):
    return torch.softmax(x, dim=axis)

def _gelu(x):
    return torch.nn.functional.gelu(x, approximate='tanh')

def _silu(x):
    return torch.nn.functional.silu(x)

def _sigmoid(x):
    return torch.sigmoid(x)

def _layernorm(x, axis=-1, eps=1e-05):
    m = x.mean(dim=axis, keepdim=True)
    v = x.var(dim=axis, keepdim=True, unbiased=False)
    return (x - m) / torch.sqrt(v + eps)

def _scatter_add(tgt, idx, src, axis=0):
    return tgt.clone().index_add_(axis, idx, src)

def _segment_sum(src, seg, n):
    out = torch.zeros((n,) + src.shape[1:], dtype=src.dtype)
    return out.index_add_(0, seg, src)

def _pad(x, pw):
    flat = tuple((v for pair in reversed(pw) for v in pair))
    return torch.nn.functional.pad(x, flat)
kernel_name = 'standalone__tensor_product_equiv_equiformer__graph'

def setup_inputs():

    _w = lambda a: (lambda t: t.to(torch.bfloat16) if t.is_floating_point() else t)(torch.as_tensor(a))
    N, deg, C, De = (10000, 64, 64, max(16, 1))
    E = N * deg
    src = (lambda lo, hi, *s: torch.randint(lo, hi, s))(0, N, E).to(torch.int64)
    dst = (lambda lo, hi, *s: torch.randint(lo, hi, s))(0, N, E).to(torch.int64)
    rvec = (lambda *s: torch.randn(*s, dtype=torch.bfloat16) * 0.05)(E, 3).to(float)
    rn = (torch.linalg.norm(rvec, dim=-1, keepdim=True) + 1e-06).to(float)
    rhat = (rvec / rn).to(float)
    eps = torch.zeros((3, 3, 3), dtype=float)
    eps[0, 1, 2] = eps[1, 2, 0] = eps[2, 0, 1] = 1.0
    eps[0, 2, 1] = eps[2, 1, 0] = eps[1, 0, 2] = -1.0
    return {'x': _w((lambda *s: torch.randn(*s, dtype=torch.bfloat16) * 0.2)(N, 4 * C).to(float)), 'rhat': _w(rhat), 'e_attr': _w((lambda *s: torch.randn(*s, dtype=torch.bfloat16) * 0.2)(E, De).to(float)), 'src': _w(src), 'dst': _w(dst), 'w_rad': _w((lambda *s: torch.randn(*s, dtype=torch.bfloat16) * 0.2)(De, 5 * C).to(float)), 'w_si0': _w((lambda *s: torch.randn(*s, dtype=torch.bfloat16) * 0.2)(2 * C, C).to(float)), 'w_si1': _w((lambda *s: torch.randn(*s, dtype=torch.bfloat16) * 0.05)(3 * C, C).to(float)), 'cg_eps': _w(eps)}

def reference(x, rhat, e_attr, src, dst, w_rad, w_si0, w_si1, cg_eps):
    N = x.shape[0]
    C = w_si0.shape[1]
    E = rhat.shape[0]
    x0 = x[:, :C].clone()
    x1 = x[:, C:].reshape(N, 3, C)
    R = (e_attr @ w_rad).reshape(E, 5, C)
    f0 = x0[src]
    f1 = x1[src]
    Y1 = rhat
    p00_0 = f0 * R[:, 0, :]
    p11_0 = torch.einsum('ejc,ej->ec', f1, Y1) * R[:, 1, :]
    p01_1 = torch.einsum('ec,ej->ejc', f0, Y1) * R[:, 2, :][:, None, :]
    p10_1 = f1 * R[:, 3, :][:, None, :]
    p11_1 = torch.einsum('ijk,ekc,ej->eic', cg_eps, f1, Y1) * R[:, 4, :][:, None, :]
    m0 = torch.concatenate([p00_0, p11_0], axis=-1) @ w_si0
    m1 = torch.einsum('ejp,pc->ejc', torch.concatenate([p01_1, p10_1, p11_1], axis=-1), w_si1)
    agg0 = _segment_sum(m0, dst, N)
    agg1 = _segment_sum(m1.reshape(E, 3 * C), dst, N).reshape(N, 3, C)
    gate = _sigmoid(agg0)
    out1 = agg1 * gate[:, None, :]
    return torch.concatenate([agg0, out1.reshape(N, 3 * C)], axis=-1)
```

```asm
; @launch kernel=tp_hist_kernel grid=(68,1,1) block=(1024,1,1) lds=8192
; @launch kernel=tp_scatter_kernel grid=(64,1,1) block=(1024,1,1) lds=8192
; @launch kernel=tp_main_kernel grid=(500,1,1) block=(256,1,1) lds=81472
.amdgcn_target "amdgcn-amd-amdhsa--gfx950"
.text
.globl tp_hist_kernel
.p2align 8
.type tp_hist_kernel,@function
tp_hist_kernel:
    s_cmp_ge_u32 s2, 68
    s_cbranch_scc1 K1_END
    s_cmp_ge_u32 s2, 64
    s_cbranch_scc1 K1_PREP
    s_load_dwordx2 s[20:21], s[0:1], 32
    s_load_dwordx2 s[22:23], s[0:1], 88
    s_waitcnt lgkmcnt(0)
    s_mov_b32 s4, s20
    s_mov_b32 s5, s21
    s_mov_b32 s6, 2560000
    s_mov_b32 s7, 0x00020000
    s_mov_b32 s8, s22
    s_mov_b32 s9, s23
    s_mov_b32 s10, 131072
    s_mov_b32 s11, 0x00020000
    v_lshlrev_b32 v1, 2, v0
    v_mov_b32 v2, 0
    v_cmp_gt_u32 vcc, 512, v0
    s_and_saveexec_b64 s[12:13], vcc
    ds_write_b32 v1, v2
    s_mov_b64 exec, s[12:13]
    s_waitcnt lgkmcnt(0)
    s_barrier
    s_mul_i32 s14, s2, 40000
    v_add_u32 v3, s14, v1
    v_add_u32 v4, 0, v3
    buffer_load_dword v10, v4, s[4:7], 0 offen
    v_add_u32 v4, 4096, v3
    buffer_load_dword v11, v4, s[4:7], 0 offen
    v_add_u32 v4, 8192, v3
    buffer_load_dword v12, v4, s[4:7], 0 offen
    v_add_u32 v4, 12288, v3
    buffer_load_dword v13, v4, s[4:7], 0 offen
    v_add_u32 v4, 16384, v3
    buffer_load_dword v14, v4, s[4:7], 0 offen
    v_add_u32 v4, 20480, v3
    buffer_load_dword v15, v4, s[4:7], 0 offen
    v_add_u32 v4, 24576, v3
    buffer_load_dword v16, v4, s[4:7], 0 offen
    v_add_u32 v4, 28672, v3
    buffer_load_dword v17, v4, s[4:7], 0 offen
    v_add_u32 v4, 32768, v3
    buffer_load_dword v18, v4, s[4:7], 0 offen
    v_add_u32 v4, 36864, v3
    buffer_load_dword v19, v4, s[4:7], 0 offen
    v_mov_b32 v5, 1
    s_waitcnt vmcnt(9)
    v_mul_u32_u24 v6, 52429, v10
    v_lshrrev_b32 v6, 20, v6
    v_min_u32 v6, 499, v6
    v_lshlrev_b32 v6, 2, v6
    ds_add_u32 v6, v5
    s_waitcnt vmcnt(8)
    v_mul_u32_u24 v6, 52429, v11
    v_lshrrev_b32 v6, 20, v6
    v_min_u32 v6, 499, v6
    v_lshlrev_b32 v6, 2, v6
    ds_add_u32 v6, v5
    s_waitcnt vmcnt(7)
    v_mul_u32_u24 v6, 52429, v12
    v_lshrrev_b32 v6, 20, v6
    v_min_u32 v6, 499, v6
    v_lshlrev_b32 v6, 2, v6
    ds_add_u32 v6, v5
    s_waitcnt vmcnt(6)
    v_mul_u32_u24 v6, 52429, v13
    v_lshrrev_b32 v6, 20, v6
    v_min_u32 v6, 499, v6
    v_lshlrev_b32 v6, 2, v6
    ds_add_u32 v6, v5
    s_waitcnt vmcnt(5)
    v_mul_u32_u24 v6, 52429, v14
    v_lshrrev_b32 v6, 20, v6
    v_min_u32 v6, 499, v6
    v_lshlrev_b32 v6, 2, v6
    ds_add_u32 v6, v5
    s_waitcnt vmcnt(4)
    v_mul_u32_u24 v6, 52429, v15
    v_lshrrev_b32 v6, 20, v6
    v_min_u32 v6, 499, v6
    v_lshlrev_b32 v6, 2, v6
    ds_add_u32 v6, v5
    s_waitcnt vmcnt(3)
    v_mul_u32_u24 v6, 52429, v16
    v_lshrrev_b32 v6, 20, v6
    v_min_u32 v6, 499, v6
    v_lshlrev_b32 v6, 2, v6
    ds_add_u32 v6, v5
    s_waitcnt vmcnt(2)
    v_mul_u32_u24 v6, 52429, v17
    v_lshrrev_b32 v6, 20, v6
    v_min_u32 v6, 499, v6
    v_lshlrev_b32 v6, 2, v6
    ds_add_u32 v6, v5
    s_waitcnt vmcnt(1)
    v_mul_u32_u24 v6, 52429, v18
    v_lshrrev_b32 v6, 20, v6
    v_min_u32 v6, 499, v6
    v_lshlrev_b32 v6, 2, v6
    ds_add_u32 v6, v5
    s_waitcnt vmcnt(0)
    v_cmp_gt_u32 vcc, 784, v0
    s_and_saveexec_b64 s[12:13], vcc
    v_mul_u32_u24 v6, 52429, v19
    v_lshrrev_b32 v6, 20, v6
    v_min_u32 v6, 499, v6
    v_lshlrev_b32 v6, 2, v6
    ds_add_u32 v6, v5
    s_mov_b64 exec, s[12:13]
    s_waitcnt lgkmcnt(0)
    s_barrier
    v_cmp_gt_u32 vcc, 500, v0
    s_and_saveexec_b64 s[12:13], vcc
    ds_read_b32 v2, v1
    s_lshl_b32 s14, s2, 11
    s_waitcnt lgkmcnt(0)
    buffer_store_dword v2, v1, s[8:11], s14 offen
    s_branch K1_END
K1_PREP:
    s_load_dwordx2 s[20:21], s[0:1], 40
    s_load_dwordx2 s[22:23], s[0:1], 48
    s_load_dwordx2 s[24:25], s[0:1], 56
    s_load_dwordx2 s[26:27], s[0:1], 88
    s_waitcnt lgkmcnt(0)
    s_mov_b32 s4, s20
    s_mov_b32 s5, s21
    s_mov_b32 s6, 10240
    s_mov_b32 s7, 0x00020000
    s_mov_b32 s8, s22
    s_mov_b32 s9, s23
    s_mov_b32 s10, 16384
    s_mov_b32 s11, 0x00020000
    s_mov_b32 s12, s24
    s_mov_b32 s13, s25
    s_mov_b32 s14, 24576
    s_mov_b32 s15, 0x00020000
    s_mov_b32 s16, s26
    s_mov_b32 s17, s27
    s_mov_b32 s18, 1048576
    s_mov_b32 s19, 0x00020000
    s_sub_u32 s3, s2, 64
    s_lshl_b32 s3, s3, 10
    v_add_u32 v1, s3, v0
    v_and_b32 v2, 63, v1
    v_and_b32 v3, 15, v2
    v_lshrrev_b32 v4, 4, v2
    v_cmp_gt_u32 vcc, 1280, v1
    s_and_saveexec_b64 s[28:29], vcc
    v_lshrrev_b32 v5, 6, v1
    v_lshrrev_b32 v6, 2, v5
    v_and_b32 v7, 3, v5
    v_lshlrev_b32 v8, 6, v6
    v_lshl_add_u32 v8, v3, 2, v8
    v_add_u32 v8, v8, v7
    v_lshlrev_b32 v9, 2, v4
    v_mul_u32_u24 v9, 640, v9
    v_lshl_add_u32 v9, v8, 1, v9
    buffer_load_ushort v10, v9, s[4:7], 0 offen offset:0
    buffer_load_ushort v11, v9, s[4:7], 0 offen offset:640
    buffer_load_ushort v12, v9, s[4:7], 0 offen offset:1280
    buffer_load_ushort v13, v9, s[4:7], 0 offen offset:1920
    s_waitcnt vmcnt(0)
    v_lshl_or_b32 v10, v11, 16, v10
    v_lshl_or_b32 v11, v13, 16, v12
    v_lshlrev_b32 v14, 3, v1
    v_add_u32 v14, 135168, v14
    buffer_store_dwordx2 v[10:11], v14, s[16:19], 0 offen
    s_mov_b64 exec, s[28:29]
    v_subrev_u32 v5, 1280, v1
    v_cmp_gt_u32 vcc, 1024, v5
    s_and_saveexec_b64 s[28:29], vcc
    v_lshrrev_b32 v6, 8, v5
    v_bfe_u32 v7, v5, 6, 2
    v_lshlrev_b32 v8, 5, v7
    v_lshl_add_u32 v8, v4, 3, v8
    v_lshlrev_b32 v8, 7, v8
    v_lshl_add_u32 v9, v6, 4, v3
    v_lshl_add_u32 v8, v9, 1, v8
    buffer_load_ushort v10, v8, s[8:11], 0 offen offset:0
    buffer_load_ushort v11, v8, s[8:11], 0 offen offset:128
    buffer_load_ushort v12, v8, s[8:11], 0 offen offset:256
    buffer_load_ushort v13, v8, s[8:11], 0 offen offset:384
    buffer_load_ushort v14, v8, s[8:11], 0 offen offset:512
    buffer_load_ushort v15, v8, s[8:11], 0 offen offset:640
    buffer_load_ushort v16, v8, s[8:11], 0 offen offset:768
    buffer_load_ushort v17, v8, s[8:11], 0 offen offset:896
    s_waitcnt vmcnt(0)
    v_lshl_or_b32 v20, v11, 16, v10
    v_lshl_or_b32 v21, v13, 16, v12
    v_lshl_or_b32 v22, v15, 16, v14
    v_lshl_or_b32 v23, v17, 16, v16
    v_lshlrev_b32 v14, 4, v5
    v_add_u32 v14, 147456, v14
    buffer_store_dwordx4 v[20:23], v14, s[16:19], 0 offen
    s_mov_b64 exec, s[28:29]
    v_subrev_u32 v5, 2304, v1
    v_cmp_gt_u32 vcc, 1536, v5
    s_and_saveexec_b64 s[28:29], vcc
    v_lshrrev_b32 v7, 8, v5
    v_bfe_u32 v6, v5, 6, 2
    v_lshlrev_b32 v8, 5, v7
    v_lshl_add_u32 v8, v4, 3, v8
    v_lshlrev_b32 v8, 7, v8
    v_lshl_add_u32 v9, v6, 4, v3
    v_lshl_add_u32 v8, v9, 1, v8
    buffer_load_ushort v10, v8, s[12:15], 0 offen offset:0
    buffer_load_ushort v11, v8, s[12:15], 0 offen offset:128
    buffer_load_ushort v12, v8, s[12:15], 0 offen offset:256
    buffer_load_ushort v13, v8, s[12:15], 0 offen offset:384
    buffer_load_ushort v14, v8, s[12:15], 0 offen offset:512
    buffer_load_ushort v15, v8, s[12:15], 0 offen offset:640
    buffer_load_ushort v16, v8, s[12:15], 0 offen offset:768
    buffer_load_ushort v17, v8, s[12:15], 0 offen offset:896
    s_waitcnt vmcnt(0)
    v_lshl_or_b32 v20, v11, 16, v10
    v_lshl_or_b32 v21, v13, 16, v12
    v_lshl_or_b32 v22, v15, 16, v14
    v_lshl_or_b32 v23, v17, 16, v16
    v_lshlrev_b32 v14, 4, v5
    v_add_u32 v14, 163840, v14
    buffer_store_dwordx4 v[20:23], v14, s[16:19], 0 offen
    s_mov_b64 exec, s[28:29]
K1_END:
    s_endpgm
.section .rodata,"a"
.p2align 6
.amdhsa_kernel tp_hist_kernel
  .amdhsa_next_free_vgpr 32
  .amdhsa_next_free_sgpr 102
  .amdhsa_accum_offset 32
  .amdhsa_group_segment_fixed_size 0
  .amdhsa_kernarg_size 96
  .amdhsa_user_sgpr_count 2
  .amdhsa_user_sgpr_kernarg_segment_ptr 1
  .amdhsa_system_sgpr_workgroup_id_x 1
.end_amdhsa_kernel
.text
.globl tp_scatter_kernel
.p2align 8
.type tp_scatter_kernel,@function
tp_scatter_kernel:
    s_cmp_ge_u32 s2, 64
    s_cbranch_scc1 K2_END
    s_load_dwordx2 s[20:21], s[0:1], 32
    s_load_dwordx2 s[22:23], s[0:1], 24
    s_load_dwordx2 s[24:25], s[0:1], 8
    s_load_dwordx2 s[26:27], s[0:1], 88
    s_waitcnt lgkmcnt(0)
    s_mov_b32 s4, s20
    s_mov_b32 s5, s21
    s_mov_b32 s6, 2560000
    s_mov_b32 s7, 0x00020000
    s_mov_b32 s8, s22
    s_mov_b32 s9, s23
    s_mov_b32 s10, 2560000
    s_mov_b32 s11, 0x00020000
    s_mov_b32 s12, s24
    s_mov_b32 s13, s25
    s_mov_b32 s14, 3840000
    s_mov_b32 s15, 0x00020000
    s_mov_b32 s16, s26
    s_mov_b32 s17, s27
    s_mov_b32 s18, 11288576
    s_mov_b32 s19, 0x00020000
    v_lshlrev_b32 v1, 2, v0
    v_mov_b32 v2, 0
    v_mov_b32 v3, 0
    v_cmp_gt_u32 vcc, 512, v0
    s_and_saveexec_b64 s[28:29], vcc
    s_cbranch_execz K2_SKIPA
    s_mov_b32 s30, 0
    buffer_load_dword v10, v1, s[16:19], s30 offen
    s_mov_b32 s30, 2048
    buffer_load_dword v11, v1, s[16:19], s30 offen
    s_mov_b32 s30, 4096
    buffer_load_dword v12, v1, s[16:19], s30 offen
    s_mov_b32 s30, 6144
    buffer_load_dword v13, v1, s[16:19], s30 offen
    s_mov_b32 s30, 8192
    buffer_load_dword v14, v1, s[16:19], s30 offen
    s_mov_b32 s30, 10240
    buffer_load_dword v15, v1, s[16:19], s30 offen
    s_mov_b32 s30, 12288
    buffer_load_dword v16, v1, s[16:19], s30 offen
    s_mov_b32 s30, 14336
    buffer_load_dword v17, v1, s[16:19], s30 offen
    s_mov_b32 s30, 16384
    buffer_load_dword v18, v1, s[16:19], s30 offen
    s_mov_b32 s30, 18432
    buffer_load_dword v19, v1, s[16:19], s30 offen
    s_mov_b32 s30, 20480
    buffer_load_dword v20, v1, s[16:19], s30 offen
    s_mov_b32 s30, 22528
    buffer_load_dword v21, v1, s[16:19], s30 offen
    s_mov_b32 s30, 24576
    buffer_load_dword v22, v1, s[16:19], s30 offen
    s_mov_b32 s30, 26624
    buffer_load_dword v23, v1, s[16:19], s30 offen
    s_mov_b32 s30, 28672
    buffer_load_dword v24, v1, s[16:19], s30 offen
    s_mov_b32 s30, 30720
    buffer_load_dword v25, v1, s[16:19], s30 offen
    s_waitcnt vmcnt(0)
    s_cmp_lg_u32 s2, 0
    s_cbranch_scc1 K2_NS0
    v_mov_b32 v3, v2
K2_NS0:
    v_add_u32 v2, v2, v10
    s_cmp_lg_u32 s2, 1
    s_cbranch_scc1 K2_NS1
    v_mov_b32 v3, v2
K2_NS1:
    v_add_u32 v2, v2, v11
    s_cmp_lg_u32 s2, 2
    s_cbranch_scc1 K2_NS2
    v_mov_b32 v3, v2
K2_NS2:
    v_add_u32 v2, v2, v12
    s_cmp_lg_u32 s2, 3
    s_cbranch_scc1 K2_NS3
    v_mov_b32 v3, v2
K2_NS3:
    v_add_u32 v2, v2, v13
    s_cmp_lg_u32 s2, 4
    s_cbranch_scc1 K2_NS4
    v_mov_b32 v3, v2
K2_NS4:
    v_add_u32 v2, v2, v14
    s_cmp_lg_u32 s2, 5
    s_cbranch_scc1 K2_NS5
    v_mov_b32 v3, v2
K2_NS5:
    v_add_u32 v2, v2, v15
    s_cmp_lg_u32 s2, 6
    s_cbranch_scc1 K2_NS6
    v_mov_b32 v3, v2
K2_NS6:
    v_add_u32 v2, v2, v16
    s_cmp_lg_u32 s2, 7
    s_cbranch_scc1 K2_NS7
    v_mov_b32 v3, v2
K2_NS7:
    v_add_u32 v2, v2, v17
    s_cmp_lg_u32 s2, 8
    s_cbranch_scc1 K2_NS8
    v_mov_b32 v3, v2
K2_NS8:
    v_add_u32 v2, v2, v18
    s_cmp_lg_u32 s2, 9
    s_cbranch_scc1 K2_NS9
    v_mov_b32 v3, v2
K2_NS9:
    v_add_u32 v2, v2, v19
    s_cmp_lg_u32 s2, 10
    s_cbranch_scc1 K2_NS10
    v_mov_b32 v3, v2
K2_NS10:
    v_add_u32 v2, v2, v20
    s_cmp_lg_u32 s2, 11
    s_cbranch_scc1 K2_NS11
    v_mov_b32 v3, v2
K2_NS11:
    v_add_u32 v2, v2, v21
    s_cmp_lg_u32 s2, 12
    s_cbranch_scc1 K2_NS12
    v_mov_b32 v3, v2
K2_NS12:
    v_add_u32 v2, v2, v22
    s_cmp_lg_u32 s2, 13
    s_cbranch_scc1 K2_NS13
    v_mov_b32 v3, v2
K2_NS13:
    v_add_u32 v2, v2, v23
    s_cmp_lg_u32 s2, 14
    s_cbranch_scc1 K2_NS14
    v_mov_b32 v3, v2
K2_NS14:
    v_add_u32 v2, v2, v24
    s_cmp_lg_u32 s2, 15
    s_cbranch_scc1 K2_NS15
    v_mov_b32 v3, v2
K2_NS15:
    v_add_u32 v2, v2, v25
    s_mov_b32 s30, 32768
    buffer_load_dword v10, v1, s[16:19], s30 offen
    s_mov_b32 s30, 34816
    buffer_load_dword v11, v1, s[16:19], s30 offen
    s_mov_b32 s30, 36864
    buffer_load_dword v12, v1, s[16:19], s30 offen
    s_mov_b32 s30, 38912
    buffer_load_dword v13, v1, s[16:19], s30 offen
    s_mov_b32 s30, 40960
    buffer_load_dword v14, v1, s[16:19], s30 offen
    s_mov_b32 s30, 43008
    buffer_load_dword v15, v1, s[16:19], s30 offen
    s_mov_b32 s30, 45056
    buffer_load_dword v16, v1, s[16:19], s30 offen
    s_mov_b32 s30, 47104
    buffer_load_dword v17, v1, s[16:19], s30 offen
    s_mov_b32 s30, 49152
    buffer_load_dword v18, v1, s[16:19], s30 offen
    s_mov_b32 s30, 51200
    buffer_load_dword v19, v1, s[16:19], s30 offen
    s_mov_b32 s30, 53248
    buffer_load_dword v20, v1, s[16:19], s30 offen
    s_mov_b32 s30, 55296
    buffer_load_dword v21, v1, s[16:19], s30 offen
    s_mov_b32 s30, 57344
    buffer_load_dword v22, v1, s[16:19], s30 offen
    s_mov_b32 s30, 59392
    buffer_load_dword v23, v1, s[16:19], s30 offen
    s_mov_b32 s30, 61440
    buffer_load_dword v24, v1, s[16:19], s30 offen
    s_mov_b32 s30, 63488
    buffer_load_dword v25, v1, s[16:19], s30 offen
    s_waitcnt vmcnt(0)
    s_cmp_lg_u32 s2, 16
    s_cbranch_scc1 K2_NS16
    v_mov_b32 v3, v2
K2_NS16:
    v_add_u32 v2, v2, v10
    s_cmp_lg_u32 s2, 17
    s_cbranch_scc1 K2_NS17
    v_mov_b32 v3, v2
K2_NS17:
    v_add_u32 v2, v2, v11
    s_cmp_lg_u32 s2, 18
    s_cbranch_scc1 K2_NS18
    v_mov_b32 v3, v2
K2_NS18:
    v_add_u32 v2, v2, v12
    s_cmp_lg_u32 s2, 19
    s_cbranch_scc1 K2_NS19
    v_mov_b32 v3, v2
K2_NS19:
    v_add_u32 v2, v2, v13
    s_cmp_lg_u32 s2, 20
    s_cbranch_scc1 K2_NS20
    v_mov_b32 v3, v2
K2_NS20:
    v_add_u32 v2, v2, v14
    s_cmp_lg_u32 s2, 21
    s_cbranch_scc1 K2_NS21
    v_mov_b32 v3, v2
K2_NS21:
    v_add_u32 v2, v2, v15
    s_cmp_lg_u32 s2, 22
    s_cbranch_scc1 K2_NS22
    v_mov_b32 v3, v2
K2_NS22:
    v_add_u32 v2, v2, v16
    s_cmp_lg_u32 s2, 23
    s_cbranch_scc1 K2_NS23
    v_mov_b32 v3, v2
K2_NS23:
    v_add_u32 v2, v2, v17
    s_cmp_lg_u32 s2, 24
    s_cbranch_scc1 K2_NS24
    v_mov_b32 v3, v2
K2_NS24:
    v_add_u32 v2, v2, v18
    s_cmp_lg_u32 s2, 25
    s_cbranch_scc1 K2_NS25
    v_mov_b32 v3, v2
K2_NS25:
    v_add_u32 v2, v2, v19
    s_cmp_lg_u32 s2, 26
    s_cbranch_scc1 K2_NS26
    v_mov_b32 v3, v2
K2_NS26:
    v_add_u32 v2, v2, v20
    s_cmp_lg_u32 s2, 27
    s_cbranch_scc1 K2_NS27
    v_mov_b32 v3, v2
K2_NS27:
    v_add_u32 v2, v2, v21
    s_cmp_lg_u32 s2, 28
    s_cbranch_scc1 K2_NS28
    v_mov_b32 v3, v2
K2_NS28:
    v_add_u32 v2, v2, v22
    s_cmp_lg_u32 s2, 29
    s_cbranch_scc1 K2_NS29
    v_mov_b32 v3, v2
K2_NS29:
    v_add_u32 v2, v2, v23
    s_cmp_lg_u32 s2, 30
    s_cbranch_scc1 K2_NS30
    v_mov_b32 v3, v2
K2_NS30:
    v_add_u32 v2, v2, v24
    s_cmp_lg_u32 s2, 31
    s_cbranch_scc1 K2_NS31
    v_mov_b32 v3, v2
K2_NS31:
    v_add_u32 v2, v2, v25
    s_mov_b32 s30, 65536
    buffer_load_dword v10, v1, s[16:19], s30 offen
    s_mov_b32 s30, 67584
    buffer_load_dword v11, v1, s[16:19], s30 offen
    s_mov_b32 s30, 69632
    buffer_load_dword v12, v1, s[16:19], s30 offen
    s_mov_b32 s30, 71680
    buffer_load_dword v13, v1, s[16:19], s30 offen
    s_mov_b32 s30, 73728
    buffer_load_dword v14, v1, s[16:19], s30 offen
    s_mov_b32 s30, 75776
    buffer_load_dword v15, v1, s[16:19], s30 offen
    s_mov_b32 s30, 77824
    buffer_load_dword v16, v1, s[16:19], s30 offen
    s_mov_b32 s30, 79872
    buffer_load_dword v17, v1, s[16:19], s30 offen
    s_mov_b32 s30, 81920
    buffer_load_dword v18, v1, s[16:19], s30 offen
    s_mov_b32 s30, 83968
    buffer_load_dword v19, v1, s[16:19], s30 offen
    s_mov_b32 s30, 86016
    buffer_load_dword v20, v1, s[16:19], s30 offen
    s_mov_b32 s30, 88064
    buffer_load_dword v21, v1, s[16:19], s30 offen
    s_mov_b32 s30, 90112
    buffer_load_dword v22, v1, s[16:19], s30 offen
    s_mov_b32 s30, 92160
    buffer_load_dword v23, v1, s[16:19], s30 offen
    s_mov_b32 s30, 94208
    buffer_load_dword v24, v1, s[16:19], s30 offen
    s_mov_b32 s30, 96256
    buffer_load_dword v25, v1, s[16:19], s30 offen
    s_waitcnt vmcnt(0)
    s_cmp_lg_u32 s2, 32
    s_cbranch_scc1 K2_NS32
    v_mov_b32 v3, v2
K2_NS32:
    v_add_u32 v2, v2, v10
    s_cmp_lg_u32 s2, 33
    s_cbranch_scc1 K2_NS33
    v_mov_b32 v3, v2
K2_NS33:
    v_add_u32 v2, v2, v11
    s_cmp_lg_u32 s2, 34
    s_cbranch_scc1 K2_NS34
    v_mov_b32 v3, v2
K2_NS34:
    v_add_u32 v2, v2, v12
    s_cmp_lg_u32 s2, 35
    s_cbranch_scc1 K2_NS35
    v_mov_b32 v3, v2
K2_NS35:
    v_add_u32 v2, v2, v13
    s_cmp_lg_u32 s2, 36
    s_cbranch_scc1 K2_NS36
    v_mov_b32 v3, v2
K2_NS36:
    v_add_u32 v2, v2, v14
    s_cmp_lg_u32 s2, 37
    s_cbranch_scc1 K2_NS37
    v_mov_b32 v3, v2
K2_NS37:
    v_add_u32 v2, v2, v15
    s_cmp_lg_u32 s2, 38
    s_cbranch_scc1 K2_NS38
    v_mov_b32 v3, v2
K2_NS38:
    v_add_u32 v2, v2, v16
    s_cmp_lg_u32 s2, 39
    s_cbranch_scc1 K2_NS39
    v_mov_b32 v3, v2
K2_NS39:
    v_add_u32 v2, v2, v17
    s_cmp_lg_u32 s2, 40
    s_cbranch_scc1 K2_NS40
    v_mov_b32 v3, v2
K2_NS40:
    v_add_u32 v2, v2, v18
    s_cmp_lg_u32 s2, 41
    s_cbranch_scc1 K2_NS41
    v_mov_b32 v3, v2
K2_NS41:
    v_add_u32 v2, v2, v19
    s_cmp_lg_u32 s2, 42
    s_cbranch_scc1 K2_NS42
    v_mov_b32 v3, v2
K2_NS42:
    v_add_u32 v2, v2, v20
    s_cmp_lg_u32 s2, 43
    s_cbranch_scc1 K2_NS43
    v_mov_b32 v3, v2
K2_NS43:
    v_add_u32 v2, v2, v21
    s_cmp_lg_u32 s2, 44
    s_cbranch_scc1 K2_NS44
    v_mov_b32 v3, v2
K2_NS44:
    v_add_u32 v2, v2, v22
    s_cmp_lg_u32 s2, 45
    s_cbranch_scc1 K2_NS45
    v_mov_b32 v3, v2
K2_NS45:
    v_add_u32 v2, v2, v23
    s_cmp_lg_u32 s2, 46
    s_cbranch_scc1 K2_NS46
    v_mov_b32 v3, v2
K2_NS46:
    v_add_u32 v2, v2, v24
    s_cmp_lg_u32 s2, 47
    s_cbranch_scc1 K2_NS47
    v_mov_b32 v3, v2
K2_NS47:
    v_add_u32 v2, v2, v25
    s_mov_b32 s30, 98304
    buffer_load_dword v10, v1, s[16:19], s30 offen
    s_mov_b32 s30, 100352
    buffer_load_dword v11, v1, s[16:19], s30 offen
    s_mov_b32 s30, 102400
    buffer_load_dword v12, v1, s[16:19], s30 offen
    s_mov_b32 s30, 104448
    buffer_load_dword v13, v1, s[16:19], s30 offen
    s_mov_b32 s30, 106496
    buffer_load_dword v14, v1, s[16:19], s30 offen
    s_mov_b32 s30, 108544
    buffer_load_dword v15, v1, s[16:19], s30 offen
    s_mov_b32 s30, 110592
    buffer_load_dword v16, v1, s[16:19], s30 offen
    s_mov_b32 s30, 112640
    buffer_load_dword v17, v1, s[16:19], s30 offen
    s_mov_b32 s30, 114688
    buffer_load_dword v18, v1, s[16:19], s30 offen
    s_mov_b32 s30, 116736
    buffer_load_dword v19, v1, s[16:19], s30 offen
    s_mov_b32 s30, 118784
    buffer_load_dword v20, v1, s[16:19], s30 offen
    s_mov_b32 s30, 120832
    buffer_load_dword v21, v1, s[16:19], s30 offen
    s_mov_b32 s30, 122880
    buffer_load_dword v22, v1, s[16:19], s30 offen
    s_mov_b32 s30, 124928
    buffer_load_dword v23, v1, s[16:19], s30 offen
    s_mov_b32 s30, 126976
    buffer_load_dword v24, v1, s[16:19], s30 offen
    s_mov_b32 s30, 129024
    buffer_load_dword v25, v1, s[16:19], s30 offen
    s_waitcnt vmcnt(0)
    s_cmp_lg_u32 s2, 48
    s_cbranch_scc1 K2_NS48
    v_mov_b32 v3, v2
K2_NS48:
    v_add_u32 v2, v2, v10
    s_cmp_lg_u32 s2, 49
    s_cbranch_scc1 K2_NS49
    v_mov_b32 v3, v2
K2_NS49:
    v_add_u32 v2, v2, v11
    s_cmp_lg_u32 s2, 50
    s_cbranch_scc1 K2_NS50
    v_mov_b32 v3, v2
K2_NS50:
    v_add_u32 v2, v2, v12
    s_cmp_lg_u32 s2, 51
    s_cbranch_scc1 K2_NS51
    v_mov_b32 v3, v2
K2_NS51:
    v_add_u32 v2, v2, v13
    s_cmp_lg_u32 s2, 52
    s_cbranch_scc1 K2_NS52
    v_mov_b32 v3, v2
K2_NS52:
    v_add_u32 v2, v2, v14
    s_cmp_lg_u32 s2, 53
    s_cbranch_scc1 K2_NS53
    v_mov_b32 v3, v2
K2_NS53:
    v_add_u32 v2, v2, v15
    s_cmp_lg_u32 s2, 54
    s_cbranch_scc1 K2_NS54
    v_mov_b32 v3, v2
K2_NS54:
    v_add_u32 v2, v2, v16
    s_cmp_lg_u32 s2, 55
    s_cbranch_scc1 K2_NS55
    v_mov_b32 v3, v2
K2_NS55:
    v_add_u32 v2, v2, v17
    s_cmp_lg_u32 s2, 56
    s_cbranch_scc1 K2_NS56
    v_mov_b32 v3, v2
K2_NS56:
    v_add_u32 v2, v2, v18
    s_cmp_lg_u32 s2, 57
    s_cbranch_scc1 K2_NS57
    v_mov_b32 v3, v2
K2_NS57:
    v_add_u32 v2, v2, v19
    s_cmp_lg_u32 s2, 58
    s_cbranch_scc1 K2_NS58
    v_mov_b32 v3, v2
K2_NS58:
    v_add_u32 v2, v2, v20
    s_cmp_lg_u32 s2, 59
    s_cbranch_scc1 K2_NS59
    v_mov_b32 v3, v2
K2_NS59:
    v_add_u32 v2, v2, v21
    s_cmp_lg_u32 s2, 60
    s_cbranch_scc1 K2_NS60
    v_mov_b32 v3, v2
K2_NS60:
    v_add_u32 v2, v2, v22
    s_cmp_lg_u32 s2, 61
    s_cbranch_scc1 K2_NS61
    v_mov_b32 v3, v2
K2_NS61:
    v_add_u32 v2, v2, v23
    s_cmp_lg_u32 s2, 62
    s_cbranch_scc1 K2_NS62
    v_mov_b32 v3, v2
K2_NS62:
    v_add_u32 v2, v2, v24
    s_cmp_lg_u32 s2, 63
    s_cbranch_scc1 K2_NS63
    v_mov_b32 v3, v2
K2_NS63:
    v_add_u32 v2, v2, v25
    v_cmp_gt_u32 vcc, 500, v0
    s_nop 1
    v_cndmask_b32 v2, 0, v2, vcc
    v_cndmask_b32 v3, 0, v3, vcc
    v_mov_b32 v4, v2
    s_nop 1
    v_add_u32_dpp v4, v4, v4 row_shr:1 row_mask:0xf bank_mask:0xf bound_ctrl:0
    s_nop 1
    v_add_u32_dpp v4, v4, v4 row_shr:2 row_mask:0xf bank_mask:0xf bound_ctrl:0
    s_nop 1
    v_add_u32_dpp v4, v4, v4 row_shr:4 row_mask:0xf bank_mask:0xf bound_ctrl:0
    s_nop 1
    v_add_u32_dpp v4, v4, v4 row_shr:8 row_mask:0xf bank_mask:0xf bound_ctrl:0
    s_nop 1
    v_add_u32_dpp v4, v4, v4 row_bcast:15 row_mask:0xa bank_mask:0xf
    s_nop 1
    v_add_u32_dpp v4, v4, v4 row_bcast:31 row_mask:0xc bank_mask:0xf
    s_nop 1
    v_readlane_b32 s31, v4, 63
    v_lshrrev_b32 v5, 6, v0
    v_lshlrev_b32 v5, 2, v5
    v_mov_b32 v6, s31
    ds_write_b32 v5, v6 offset:4096
K2_SKIPA:
    s_mov_b64 exec, s[28:29]
    s_waitcnt lgkmcnt(0)
    s_barrier
    v_cmp_gt_u32 vcc, 512, v0
    s_and_saveexec_b64 s[28:29], vcc
    s_cbranch_execz K2_SKIPB
    v_mov_b32 v5, 0
    ds_read_b128 v[8:11], v5 offset:4096
    ds_read_b128 v[12:15], v5 offset:4112
    v_lshrrev_b32 v6, 6, v0
    s_nop 0
    v_readfirstlane_b32 s32, v6
    s_waitcnt lgkmcnt(0)
    s_mov_b32 s33, 0
    v_readfirstlane_b32 s34, v8
    s_nop 3
    s_cmp_gt_u32 s32, 0
    s_cselect_b32 s34, s34, 0
    s_add_u32 s33, s33, s34
    v_readfirstlane_b32 s34, v9
    s_nop 3
    s_cmp_gt_u32 s32, 1
    s_cselect_b32 s34, s34, 0
    s_add_u32 s33, s33, s34
    v_readfirstlane_b32 s34, v10
    s_nop 3
    s_cmp_gt_u32 s32, 2
    s_cselect_b32 s34, s34, 0
    s_add_u32 s33, s33, s34
    v_readfirstlane_b32 s34, v11
    s_nop 3
    s_cmp_gt_u32 s32, 3
    s_cselect_b32 s34, s34, 0
    s_add_u32 s33, s33, s34
    v_readfirstlane_b32 s34, v12
    s_nop 3
    s_cmp_gt_u32 s32, 4
    s_cselect_b32 s34, s34, 0
    s_add_u32 s33, s33, s34
    v_readfirstlane_b32 s34, v13
    s_nop 3
    s_cmp_gt_u32 s32, 5
    s_cselect_b32 s34, s34, 0
    s_add_u32 s33, s33, s34
    v_readfirstlane_b32 s34, v14
    s_nop 3
    s_cmp_gt_u32 s32, 6
    s_cselect_b32 s34, s34, 0
    s_add_u32 s33, s33, s34
    v_readfirstlane_b32 s34, v15
    s_nop 3
    s_cmp_gt_u32 s32, 7
    s_cselect_b32 s34, s34, 0
    s_add_u32 s33, s33, s34
    v_sub_u32 v4, v4, v2
    v_add_u32 v4, s33, v4
    v_add_u32 v7, v4, v3
    ds_write_b32 v1, v7
    s_cmp_lg_u32 s2, 0
    s_cbranch_scc1 K2_SKIPB
    v_cmp_gt_u32 vcc, 500, v0
    s_and_saveexec_b64 s[34:35], vcc
    v_add_u32 v5, 131072, v1
    buffer_store_dword v4, v5, s[16:19], 0 offen
    v_cmp_eq_u32 vcc, 499, v0
    s_and_saveexec_b64 s[36:37], vcc
    v_add_u32 v4, v4, v2
    buffer_store_dword v4, v5, s[16:19], 0 offen offset:4
K2_SKIPB:
    s_mov_b64 exec, s[28:29]
    s_waitcnt vmcnt(0) lgkmcnt(0)
    s_barrier
    s_mul_i32 s30, s2, 10000
    v_mov_b32 v5, 1
    v_add_u32 v6, 0, v0
    v_add_u32 v6, s30, v6
    v_lshlrev_b32 v7, 2, v6
    buffer_load_dword v8, v7, s[4:7], 0 offen
    buffer_load_dword v9, v7, s[8:11], 0 offen
    v_mul_u32_u24 v10, 6, v6
    v_and_b32 v11, 0xfffffffc, v10
    buffer_load_dwordx2 v[12:13], v11, s[12:15], 0 offen
    v_and_b32 v10, 3, v10
    v_lshlrev_b32 v10, 3, v10
    s_waitcnt vmcnt(0)
    v_mul_u32_u24 v14, 52429, v8
    v_lshrrev_b32 v14, 20, v14
    v_min_u32 v14, 499, v14
    v_mul_u32_u24 v15, 20, v14
    v_sub_u32 v15, v8, v15
    v_and_b32 v15, 31, v15
    v_lshlrev_b32 v14, 2, v14
    ds_add_rtn_u32 v16, v14, v5
    v_lshl_or_b32 v20, v6, 5, v15
    v_mov_b32 v21, v9
    v_lshrrev_b64 v[12:13], v10, v[12:13]
    v_mov_b32 v22, v12
    v_and_b32 v23, 0xffff, v13
    s_waitcnt lgkmcnt(0)
    v_lshlrev_b32 v16, 4, v16
    v_add_u32 v16, 1048576, v16
    buffer_store_dwordx4 v[20:23], v16, s[16:19], 0 offen
    s_nop 1
    v_add_u32 v6, 1024, v0
    v_add_u32 v6, s30, v6
    v_lshlrev_b32 v7, 2, v6
    buffer_load_dword v8, v7, s[4:7], 0 offen
    buffer_load_dword v9, v7, s[8:11], 0 offen
    v_mul_u32_u24 v10, 6, v6
    v_and_b32 v11, 0xfffffffc, v10
    buffer_load_dwordx2 v[12:13], v11, s[12:15], 0 offen
    v_and_b32 v10, 3, v10
    v_lshlrev_b32 v10, 3, v10
    s_waitcnt vmcnt(0)
    v_mul_u32_u24 v14, 52429, v8
    v_lshrrev_b32 v14, 20, v14
    v_min_u32 v14, 499, v14
    v_mul_u32_u24 v15, 20, v14
    v_sub_u32 v15, v8, v15
    v_and_b32 v15, 31, v15
    v_lshlrev_b32 v14, 2, v14
    ds_add_rtn_u32 v16, v14, v5
    v_lshl_or_b32 v20, v6, 5, v15
    v_mov_b32 v21, v9
    v_lshrrev_b64 v[12:13], v10, v[12:13]
    v_mov_b32 v22, v12
    v_and_b32 v23, 0xffff, v13
    s_waitcnt lgkmcnt(0)
    v_lshlrev_b32 v16, 4, v16
    v_add_u32 v16, 1048576, v16
    buffer_store_dwordx4 v[20:23], v16, s[16:19], 0 offen
    s_nop 1
    v_add_u32 v6, 2048, v0
    v_add_u32 v6, s30, v6
    v_lshlrev_b32 v7, 2, v6
    buffer_load_dword v8, v7, s[4:7], 0 offen
    buffer_load_dword v9, v7, s[8:11], 0 offen
    v_mul_u32_u24 v10, 6, v6
    v_and_b32 v11, 0xfffffffc, v10
    buffer_load_dwordx2 v[12:13], v11, s[12:15], 0 offen
    v_and_b32 v10, 3, v10
    v_lshlrev_b32 v10, 3, v10
    s_waitcnt vmcnt(0)
    v_mul_u32_u24 v14, 52429, v8
    v_lshrrev_b32 v14, 20, v14
    v_min_u32 v14, 499, v14
    v_mul_u32_u24 v15, 20, v14
    v_sub_u32 v15, v8, v15
    v_and_b32 v15, 31, v15
    v_lshlrev_b32 v14, 2, v14
    ds_add_rtn_u32 v16, v14, v5
    v_lshl_or_b32 v20, v6, 5, v15
    v_mov_b32 v21, v9
    v_lshrrev_b64 v[12:13], v10, v[12:13]
    v_mov_b32 v22, v12
    v_and_b32 v23, 0xffff, v13
    s_waitcnt lgkmcnt(0)
    v_lshlrev_b32 v16, 4, v16
    v_add_u32 v16, 1048576, v16
    buffer_store_dwordx4 v[20:23], v16, s[16:19], 0 offen
    s_nop 1
    v_add_u32 v6, 3072, v0
    v_add_u32 v6, s30, v6
    v_lshlrev_b32 v7, 2, v6
    buffer_load_dword v8, v7, s[4:7], 0 offen
    buffer_load_dword v9, v7, s[8:11], 0 offen
    v_mul_u32_u24 v10, 6, v6
    v_and_b32 v11, 0xfffffffc, v10
    buffer_load_dwordx2 v[12:13], v11, s[12:15], 0 offen
    v_and_b32 v10, 3, v10
    v_lshlrev_b32 v10, 3, v10
    s_waitcnt vmcnt(0)
    v_mul_u32_u24 v14, 52429, v8
    v_lshrrev_b32 v14, 20, v14
    v_min_u32 v14, 499, v14
    v_mul_u32_u24 v15, 20, v14
    v_sub_u32 v15, v8, v15
    v_and_b32 v15, 31, v15
    v_lshlrev_b32 v14, 2, v14
    ds_add_rtn_u32 v16, v14, v5
    v_lshl_or_b32 v20, v6, 5, v15
    v_mov_b32 v21, v9
    v_lshrrev_b64 v[12:13], v10, v[12:13]
    v_mov_b32 v22, v12
    v_and_b32 v23, 0xffff, v13
    s_waitcnt lgkmcnt(0)
    v_lshlrev_b32 v16, 4, v16
    v_add_u32 v16, 1048576, v16
    buffer_store_dwordx4 v[20:23], v16, s[16:19], 0 offen
    s_nop 1
    v_add_u32 v6, 4096, v0
    v_add_u32 v6, s30, v6
    v_lshlrev_b32 v7, 2, v6
    buffer_load_dword v8, v7, s[4:7], 0 offen
    buffer_load_dword v9, v7, s[8:11], 0 offen
    v_mul_u32_u24 v10, 6, v6
    v_and_b32 v11, 0xfffffffc, v10
    buffer_load_dwordx2 v[12:13], v11, s[12:15], 0 offen
    v_and_b32 v10, 3, v10
    v_lshlrev_b32 v10, 3, v10
    s_waitcnt vmcnt(0)
    v_mul_u32_u24 v14, 52429, v8
    v_lshrrev_b32 v14, 20, v14
    v_min_u32 v14, 499, v14
    v_mul_u32_u24 v15, 20, v14
    v_sub_u32 v15, v8, v15
    v_and_b32 v15, 31, v15
    v_lshlrev_b32 v14, 2, v14
    ds_add_rtn_u32 v16, v14, v5
    v_lshl_or_b32 v20, v6, 5, v15
    v_mov_b32 v21, v9
    v_lshrrev_b64 v[12:13], v10, v[12:13]
    v_mov_b32 v22, v12
    v_and_b32 v23, 0xffff, v13
    s_waitcnt lgkmcnt(0)
    v_lshlrev_b32 v16, 4, v16
    v_add_u32 v16, 1048576, v16
    buffer_store_dwordx4 v[20:23], v16, s[16:19], 0 offen
    s_nop 1
    v_add_u32 v6, 5120, v0
    v_add_u32 v6, s30, v6
    v_lshlrev_b32 v7, 2, v6
    buffer_load_dword v8, v7, s[4:7], 0 offen
    buffer_load_dword v9, v7, s[8:11], 0 offen
    v_mul_u32_u24 v10, 6, v6
    v_and_b32 v11, 0xfffffffc, v10
    buffer_load_dwordx2 v[12:13], v11, s[12:15], 0 offen
    v_and_b32 v10, 3, v10
    v_lshlrev_b32 v10, 3, v10
    s_waitcnt vmcnt(0)
    v_mul_u32_u24 v14, 52429, v8
    v_lshrrev_b32 v14, 20, v14
    v_min_u32 v14, 499, v14
    v_mul_u32_u24 v15, 20, v14
    v_sub_u32 v15, v8, v15
    v_and_b32 v15, 31, v15
    v_lshlrev_b32 v14, 2, v14
    ds_add_rtn_u32 v16, v14, v5
    v_lshl_or_b32 v20, v6, 5, v15
    v_mov_b32 v21, v9
    v_lshrrev_b64 v[12:13], v10, v[12:13]
    v_mov_b32 v22, v12
    v_and_b32 v23, 0xffff, v13
    s_waitcnt lgkmcnt(0)
    v_lshlrev_b32 v16, 4, v16
    v_add_u32 v16, 1048576, v16
    buffer_store_dwordx4 v[20:23], v16, s[16:19], 0 offen
    s_nop 1
    v_add_u32 v6, 6144, v0
    v_add_u32 v6, s30, v6
    v_lshlrev_b32 v7, 2, v6
    buffer_load_dword v8, v7, s[4:7], 0 offen
    buffer_load_dword v9, v7, s[8:11], 0 offen
    v_mul_u32_u24 v10, 6, v6
    v_and_b32 v11, 0xfffffffc, v10
    buffer_load_dwordx2 v[12:13], v11, s[12:15], 0 offen
    v_and_b32 v10, 3, v10
    v_lshlrev_b32 v10, 3, v10
    s_waitcnt vmcnt(0)
    v_mul_u32_u24 v14, 52429, v8
    v_lshrrev_b32 v14, 20, v14
    v_min_u32 v14, 499, v14
    v_mul_u32_u24 v15, 20, v14
    v_sub_u32 v15, v8, v15
    v_and_b32 v15, 31, v15
    v_lshlrev_b32 v14, 2, v14
    ds_add_rtn_u32 v16, v14, v5
    v_lshl_or_b32 v20, v6, 5, v15
    v_mov_b32 v21, v9
    v_lshrrev_b64 v[12:13], v10, v[12:13]
    v_mov_b32 v22, v12
    v_and_b32 v23, 0xffff, v13
    s_waitcnt lgkmcnt(0)
    v_lshlrev_b32 v16, 4, v16
    v_add_u32 v16, 1048576, v16
    buffer_store_dwordx4 v[20:23], v16, s[16:19], 0 offen
    s_nop 1
    v_add_u32 v6, 7168, v0
    v_add_u32 v6, s30, v6
    v_lshlrev_b32 v7, 2, v6
    buffer_load_dword v8, v7, s[4:7], 0 offen
    buffer_load_dword v9, v7, s[8:11], 0 offen
    v_mul_u32_u24 v10, 6, v6
    v_and_b32 v11, 0xfffffffc, v10
    buffer_load_dwordx2 v[12:13], v11, s[12:15], 0 offen
    v_and_b32 v10, 3, v10
    v_lshlrev_b32 v10, 3, v10
    s_waitcnt vmcnt(0)
    v_mul_u32_u24 v14, 52429, v8
    v_lshrrev_b32 v14, 20, v14
    v_min_u32 v14, 499, v14
    v_mul_u32_u24 v15, 20, v14
    v_sub_u32 v15, v8, v15
    v_and_b32 v15, 31, v15
    v_lshlrev_b32 v14, 2, v14
    ds_add_rtn_u32 v16, v14, v5
    v_lshl_or_b32 v20, v6, 5, v15
    v_mov_b32 v21, v9
    v_lshrrev_b64 v[12:13], v10, v[12:13]
    v_mov_b32 v22, v12
    v_and_b32 v23, 0xffff, v13
    s_waitcnt lgkmcnt(0)
    v_lshlrev_b32 v16, 4, v16
    v_add_u32 v16, 1048576, v16
    buffer_store_dwordx4 v[20:23], v16, s[16:19], 0 offen
    s_nop 1
    v_add_u32 v6, 8192, v0
    v_add_u32 v6, s30, v6
    v_lshlrev_b32 v7, 2, v6
    buffer_load_dword v8, v7, s[4:7], 0 offen
    buffer_load_dword v9, v7, s[8:11], 0 offen
    v_mul_u32_u24 v10, 6, v6
    v_and_b32 v11, 0xfffffffc, v10
    buffer_load_dwordx2 v[12:13], v11, s[12:15], 0 offen
    v_and_b32 v10, 3, v10
    v_lshlrev_b32 v10, 3, v10
    s_waitcnt vmcnt(0)
    v_mul_u32_u24 v14, 52429, v8
    v_lshrrev_b32 v14, 20, v14
    v_min_u32 v14, 499, v14
    v_mul_u32_u24 v15, 20, v14
    v_sub_u32 v15, v8, v15
    v_and_b32 v15, 31, v15
    v_lshlrev_b32 v14, 2, v14
    ds_add_rtn_u32 v16, v14, v5
    v_lshl_or_b32 v20, v6, 5, v15
    v_mov_b32 v21, v9
    v_lshrrev_b64 v[12:13], v10, v[12:13]
    v_mov_b32 v22, v12
    v_and_b32 v23, 0xffff, v13
    s_waitcnt lgkmcnt(0)
    v_lshlrev_b32 v16, 4, v16
    v_add_u32 v16, 1048576, v16
    buffer_store_dwordx4 v[20:23], v16, s[16:19], 0 offen
    s_nop 1
    v_cmp_gt_u32 vcc, 784, v0
    s_and_saveexec_b64 s[28:29], vcc
    v_add_u32 v6, 9216, v0
    v_add_u32 v6, s30, v6
    v_lshlrev_b32 v7, 2, v6
    buffer_load_dword v8, v7, s[4:7], 0 offen
    buffer_load_dword v9, v7, s[8:11], 0 offen
    v_mul_u32_u24 v10, 6, v6
    v_and_b32 v11, 0xfffffffc, v10
    buffer_load_dwordx2 v[12:13], v11, s[12:15], 0 offen
    v_and_b32 v10, 3, v10
    v_lshlrev_b32 v10, 3, v10
    s_waitcnt vmcnt(0)
    v_mul_u32_u24 v14, 52429, v8
    v_lshrrev_b32 v14, 20, v14
    v_min_u32 v14, 499, v14
    v_mul_u32_u24 v15, 20, v14
    v_sub_u32 v15, v8, v15
    v_and_b32 v15, 31, v15
    v_lshlrev_b32 v14, 2, v14
    ds_add_rtn_u32 v16, v14, v5
    v_lshl_or_b32 v20, v6, 5, v15
    v_mov_b32 v21, v9
    v_lshrrev_b64 v[12:13], v10, v[12:13]
    v_mov_b32 v22, v12
    v_and_b32 v23, 0xffff, v13
    s_waitcnt lgkmcnt(0)
    v_lshlrev_b32 v16, 4, v16
    v_add_u32 v16, 1048576, v16
    buffer_store_dwordx4 v[20:23], v16, s[16:19], 0 offen
    s_nop 1
K2_END:
    s_endpgm
.section .rodata,"a"
.p2align 6
.amdhsa_kernel tp_scatter_kernel
  .amdhsa_next_free_vgpr 32
  .amdhsa_next_free_sgpr 102
  .amdhsa_accum_offset 32
  .amdhsa_group_segment_fixed_size 0
  .amdhsa_kernarg_size 96
  .amdhsa_user_sgpr_count 2
  .amdhsa_user_sgpr_kernarg_segment_ptr 1
  .amdhsa_system_sgpr_workgroup_id_x 1
.end_amdhsa_kernel
.text
.globl tp_main_kernel
.p2align 8
.type tp_main_kernel,@function
tp_main_kernel:
    s_cmp_ge_u32 s2, 500
    s_cbranch_scc1 M_END
    s_load_dwordx2 s[20:21], s[0:1], 0
    s_load_dwordx2 s[22:23], s[0:1], 16
    s_load_dwordx2 s[24:25], s[0:1], 88
    s_load_dwordx2 s[26:27], s[0:1], 72
    s_waitcnt lgkmcnt(0)
    s_mov_b32 s4, s20
    s_mov_b32 s5, s21
    s_mov_b32 s6, 5120000
    s_mov_b32 s7, 0x00020000
    s_mov_b32 s8, s22
    s_mov_b32 s9, s23
    s_mov_b32 s10, 20480000
    s_mov_b32 s11, 0x00020000
    s_mov_b32 s12, s24
    s_mov_b32 s13, s25
    s_mov_b32 s14, 11288576
    s_mov_b32 s15, 0x00020000
    s_mov_b32 s16, s26
    s_mov_b32 s17, s27
    s_mov_b32 s18, 5120000
    s_mov_b32 s19, 0x00020000
    s_lshl_b32 s3, s2, 2
    s_add_u32 s3, s3, 131072
    s_load_dwordx2 s[28:29], s[24:25], s3
    v_and_b32 v6, 63, v0
    v_and_b32 v1, 15, v6
    v_lshrrev_b32 v7, 4, v6
    v_lshlrev_b32 v2, 2, v7
    v_lshlrev_b32 v3, 3, v7
    v_lshlrev_b32 v4, 3, v1
    v_lshlrev_b32 v5, 4, v1
    v_lshlrev_b32 v7, 3, v6
    v_add_u32 v8, 135168, v7
    buffer_load_dwordx2 v[16:17], v8, s[12:15], 0 offen
    v_add_u32 v8, 135680, v7
    buffer_load_dwordx2 v[18:19], v8, s[12:15], 0 offen
    v_add_u32 v8, 136192, v7
    buffer_load_dwordx2 v[20:21], v8, s[12:15], 0 offen
    v_add_u32 v8, 136704, v7
    buffer_load_dwordx2 v[22:23], v8, s[12:15], 0 offen
    v_add_u32 v8, 137216, v7
    buffer_load_dwordx2 v[24:25], v8, s[12:15], 0 offen
    v_add_u32 v8, 137728, v7
    buffer_load_dwordx2 v[26:27], v8, s[12:15], 0 offen
    v_add_u32 v8, 138240, v7
    buffer_load_dwordx2 v[28:29], v8, s[12:15], 0 offen
    v_add_u32 v8, 138752, v7
    buffer_load_dwordx2 v[30:31], v8, s[12:15], 0 offen
    v_add_u32 v8, 139264, v7
    buffer_load_dwordx2 v[32:33], v8, s[12:15], 0 offen
    v_add_u32 v8, 139776, v7
    buffer_load_dwordx2 v[34:35], v8, s[12:15], 0 offen
    v_add_u32 v8, 140288, v7
    buffer_load_dwordx2 v[36:37], v8, s[12:15], 0 offen
    v_add_u32 v8, 140800, v7
    buffer_load_dwordx2 v[38:39], v8, s[12:15], 0 offen
    v_add_u32 v8, 141312, v7
    buffer_load_dwordx2 v[40:41], v8, s[12:15], 0 offen
    v_add_u32 v8, 141824, v7
    buffer_load_dwordx2 v[42:43], v8, s[12:15], 0 offen
    v_add_u32 v8, 142336, v7
    buffer_load_dwordx2 v[44:45], v8, s[12:15], 0 offen
    v_add_u32 v8, 142848, v7
    buffer_load_dwordx2 v[46:47], v8, s[12:15], 0 offen
    v_add_u32 v8, 143360, v7
    buffer_load_dwordx2 v[48:49], v8, s[12:15], 0 offen
    v_add_u32 v8, 143872, v7
    buffer_load_dwordx2 v[50:51], v8, s[12:15], 0 offen
    v_add_u32 v8, 144384, v7
    buffer_load_dwordx2 v[52:53], v8, s[12:15], 0 offen
    v_add_u32 v8, 144896, v7
    buffer_load_dwordx2 v[54:55], v8, s[12:15], 0 offen
    v_lshlrev_b32 v7, 4, v0
    v_mov_b32 v100, 0
    v_mov_b32 v101, 0
    v_mov_b32 v102, 0
    v_mov_b32 v103, 0
    ds_write_b128 v7, v[100:103] offset:256
    ds_write_b128 v7, v[100:103] offset:4352
    ds_write_b128 v7, v[100:103] offset:8448
    ds_write_b128 v7, v[100:103] offset:12544
    ds_write_b128 v7, v[100:103] offset:16640
    ds_write_b128 v7, v[100:103] offset:20736
    ds_write_b128 v7, v[100:103] offset:24832
    ds_write_b128 v7, v[100:103] offset:28928
    ds_write_b128 v7, v[100:103] offset:33024
    ds_write_b128 v7, v[100:103] offset:37120
    ds_write_b128 v7, v[100:103] offset:41216
    ds_write_b128 v7, v[100:103] offset:45312
    ds_write_b128 v7, v[100:103] offset:49408
    v_cmp_gt_u32 vcc, 212, v0
    s_and_saveexec_b64 s[30:31], vcc
    ds_write_b128 v7, v[100:103] offset:53504
    s_mov_b64 exec, s[30:31]
    v_mov_b32 v56, 0
    v_mov_b32 v60, 0
    v_mov_b32 v64, 0
    v_mov_b32 v68, 0
    v_mov_b32 v72, 0
    v_mov_b32 v76, 0
    v_mov_b32 v80, 0
    v_mov_b32 v84, 0
    v_mov_b32 v88, 0
    v_mov_b32 v92, 0
    v_mov_b32 v96, 0
    v_mov_b32 v57, 0
    v_mov_b32 v61, 0
    v_mov_b32 v65, 0
    v_mov_b32 v69, 0
    v_mov_b32 v73, 0
    v_mov_b32 v77, 0
    v_mov_b32 v81, 0
    v_mov_b32 v85, 0
    v_mov_b32 v89, 0
    v_mov_b32 v93, 0
    v_mov_b32 v97, 0
    v_mov_b32 v58, 0
    v_mov_b32 v62, 0
    v_mov_b32 v66, 0
    v_mov_b32 v70, 0
    v_mov_b32 v74, 0
    v_mov_b32 v78, 0
    v_mov_b32 v82, 0
    v_mov_b32 v86, 0
    v_mov_b32 v90, 0
    v_mov_b32 v94, 0
    v_mov_b32 v98, 0
    v_mov_b32 v59, 0
    v_mov_b32 v63, 0
    v_mov_b32 v67, 0
    v_mov_b32 v71, 0
    v_mov_b32 v75, 0
    v_mov_b32 v79, 0
    v_mov_b32 v83, 0
    v_mov_b32 v87, 0
    v_mov_b32 v91, 0
    v_mov_b32 v95, 0
    v_mov_b32 v99, 0
    v_lshrrev_b32 v7, 6, v0
    s_nop 0
    v_readfirstlane_b32 s44, v7
    s_waitcnt lgkmcnt(0)
M_PASS:
    s_sub_u32 s45, s29, s28
    s_min_u32 s45, s45, 1536
    v_cmp_gt_u32 vcc, 32, v0
    s_and_saveexec_b64 s[30:31], vcc
    v_lshlrev_b32 v7, 2, v0
    v_mov_b32 v8, 0
    ds_write_b32 v7, v8 offset:0
    s_mov_b64 exec, s[30:31]
    s_waitcnt lgkmcnt(0)
    s_barrier
    v_add_u32 v7, 0, v0
    v_add_u32 v8, s28, v7
    v_lshlrev_b32 v8, 4, v8
    v_add_u32 v8, 1048576, v8
    buffer_load_dwordx4 v[100:103], v8, s[12:15], 0 offen
    v_add_u32 v7, 256, v0
    v_add_u32 v8, s28, v7
    v_lshlrev_b32 v8, 4, v8
    v_add_u32 v8, 1048576, v8
    buffer_load_dwordx4 v[104:107], v8, s[12:15], 0 offen
    v_add_u32 v7, 512, v0
    v_add_u32 v8, s28, v7
    v_lshlrev_b32 v8, 4, v8
    v_add_u32 v8, 1048576, v8
    buffer_load_dwordx4 v[108:111], v8, s[12:15], 0 offen
    v_add_u32 v7, 768, v0
    v_add_u32 v8, s28, v7
    v_lshlrev_b32 v8, 4, v8
    v_add_u32 v8, 1048576, v8
    buffer_load_dwordx4 v[112:115], v8, s[12:15], 0 offen
    v_add_u32 v7, 1024, v0
    v_add_u32 v8, s28, v7
    v_lshlrev_b32 v8, 4, v8
    v_add_u32 v8, 1048576, v8
    buffer_load_dwordx4 v[116:119], v8, s[12:15], 0 offen
    v_add_u32 v7, 1280, v0
    v_add_u32 v8, s28, v7
    v_lshlrev_b32 v8, 4, v8
    v_add_u32 v8, 1048576, v8
    buffer_load_dwordx4 v[120:123], v8, s[12:15], 0 offen
    v_mov_b32 v9, 1
    s_waitcnt vmcnt(5)
    v_add_u32 v7, 0, v0
    v_cmp_gt_u32 vcc, s45, v7
    s_and_saveexec_b64 s[30:31], vcc
    v_and_b32 v8, 31, v100
    v_lshlrev_b32 v8, 2, v8
    ds_add_rtn_u32 v124, v8, v9 offset:0
    s_mov_b64 exec, s[30:31]
    s_waitcnt vmcnt(4)
    v_add_u32 v7, 256, v0
    v_cmp_gt_u32 vcc, s45, v7
    s_and_saveexec_b64 s[30:31], vcc
    v_and_b32 v8, 31, v104
    v_lshlrev_b32 v8, 2, v8
    ds_add_rtn_u32 v125, v8, v9 offset:0
    s_mov_b64 exec, s[30:31]
    s_waitcnt vmcnt(3)
    v_add_u32 v7, 512, v0
    v_cmp_gt_u32 vcc, s45, v7
    s_and_saveexec_b64 s[30:31], vcc
    v_and_b32 v8, 31, v108
    v_lshlrev_b32 v8, 2, v8
    ds_add_rtn_u32 v126, v8, v9 offset:0
    s_mov_b64 exec, s[30:31]
    s_waitcnt vmcnt(2)
    v_add_u32 v7, 768, v0
    v_cmp_gt_u32 vcc, s45, v7
    s_and_saveexec_b64 s[30:31], vcc
    v_and_b32 v8, 31, v112
    v_lshlrev_b32 v8, 2, v8
    ds_add_rtn_u32 v127, v8, v9 offset:0
    s_mov_b64 exec, s[30:31]
    s_waitcnt vmcnt(1)
    v_add_u32 v7, 1024, v0
    v_cmp_gt_u32 vcc, s45, v7
    s_and_saveexec_b64 s[30:31], vcc
    v_and_b32 v8, 31, v116
    v_lshlrev_b32 v8, 2, v8
    ds_add_rtn_u32 v128, v8, v9 offset:0
    s_mov_b64 exec, s[30:31]
    s_waitcnt vmcnt(0)
    v_add_u32 v7, 1280, v0
    v_cmp_gt_u32 vcc, s45, v7
    s_and_saveexec_b64 s[30:31], vcc
    v_and_b32 v8, 31, v120
    v_lshlrev_b32 v8, 2, v8
    ds_add_rtn_u32 v129, v8, v9 offset:0
    s_mov_b64 exec, s[30:31]
    s_waitcnt lgkmcnt(0)
    s_barrier
    v_and_b32 v7, 31, v0
    v_lshlrev_b32 v7, 2, v7
    ds_read_b32 v8, v7 offset:0
    s_waitcnt lgkmcnt(0)
    s_mov_b32 s46, 0
    v_mov_b32 v9, 0
    v_writelane_b32 v9, s46, 0
    v_readlane_b32 s47, v8, 0
    s_nop 3
    s_add_u32 s46, s46, s47
    v_writelane_b32 v9, s46, 1
    v_readlane_b32 s47, v8, 1
    s_nop 3
    s_add_u32 s46, s46, s47
    v_writelane_b32 v9, s46, 2
    v_readlane_b32 s47, v8, 2
    s_nop 3
    s_add_u32 s46, s46, s47
    v_writelane_b32 v9, s46, 3
    v_readlane_b32 s47, v8, 3
    s_nop 3
    s_add_u32 s46, s46, s47
    v_writelane_b32 v9, s46, 4
    v_readlane_b32 s47, v8, 4
    s_nop 3
    s_add_u32 s46, s46, s47
    v_writelane_b32 v9, s46, 5
    v_readlane_b32 s47, v8, 5
    s_nop 3
    s_add_u32 s46, s46, s47
    v_writelane_b32 v9, s46, 6
    v_readlane_b32 s47, v8, 6
    s_nop 3
    s_add_u32 s46, s46, s47
    v_writelane_b32 v9, s46, 7
    v_readlane_b32 s47, v8, 7
    s_nop 3
    s_add_u32 s46, s46, s47
    v_writelane_b32 v9, s46, 8
    v_readlane_b32 s47, v8, 8
    s_nop 3
    s_add_u32 s46, s46, s47
    v_writelane_b32 v9, s46, 9
    v_readlane_b32 s47, v8, 9
    s_nop 3
    s_add_u32 s46, s46, s47
    v_writelane_b32 v9, s46, 10
    v_readlane_b32 s47, v8, 10
    s_nop 3
    s_add_u32 s46, s46, s47
    v_writelane_b32 v9, s46, 11
    v_readlane_b32 s47, v8, 11
    s_nop 3
    s_add_u32 s46, s46, s47
    v_writelane_b32 v9, s46, 12
    v_readlane_b32 s47, v8, 12
    s_nop 3
    s_add_u32 s46, s46, s47
    v_writelane_b32 v9, s46, 13
    v_readlane_b32 s47, v8, 13
    s_nop 3
    s_add_u32 s46, s46, s47
    v_writelane_b32 v9, s46, 14
    v_readlane_b32 s47, v8, 14
    s_nop 3
    s_add_u32 s46, s46, s47
    v_writelane_b32 v9, s46, 15
    v_readlane_b32 s47, v8, 15
    s_nop 3
    s_add_u32 s46, s46, s47
    v_writelane_b32 v9, s46, 16
    v_readlane_b32 s47, v8, 16
    s_nop 3
    s_add_u32 s46, s46, s47
    v_writelane_b32 v9, s46, 17
    v_readlane_b32 s47, v8, 17
    s_nop 3
    s_add_u32 s46, s46, s47
    v_writelane_b32 v9, s46, 18
    v_readlane_b32 s47, v8, 18
    s_nop 3
    s_add_u32 s46, s46, s47
    v_writelane_b32 v9, s46, 19
    v_readlane_b32 s47, v8, 19
    s_nop 3
    s_add_u32 s46, s46, s47
    v_writelane_b32 v9, s46, 20
    v_and_b32 v10, 31, v100
    v_lshlrev_b32 v10, 2, v10
    ds_bpermute_b32 v11, v10, v9
    v_add_u32 v7, 0, v0
    v_cmp_gt_u32 vcc, s45, v7
    s_and_saveexec_b64 s[30:31], vcc
    s_waitcnt lgkmcnt(0)
    v_add_u32 v11, v11, v124
    v_lshlrev_b32 v11, 4, v11
    ds_write_b128 v11, v[100:103] offset:56896
    s_mov_b64 exec, s[30:31]
    v_and_b32 v10, 31, v104
    v_lshlrev_b32 v10, 2, v10
    ds_bpermute_b32 v11, v10, v9
    v_add_u32 v7, 256, v0
    v_cmp_gt_u32 vcc, s45, v7
    s_and_saveexec_b64 s[30:31], vcc
    s_waitcnt lgkmcnt(0)
    v_add_u32 v11, v11, v125
    v_lshlrev_b32 v11, 4, v11
    ds_write_b128 v11, v[104:107] offset:56896
    s_mov_b64 exec, s[30:31]
    v_and_b32 v10, 31, v108
    v_lshlrev_b32 v10, 2, v10
    ds_bpermute_b32 v11, v10, v9
    v_add_u32 v7, 512, v0
    v_cmp_gt_u32 vcc, s45, v7
    s_and_saveexec_b64 s[30:31], vcc
    s_waitcnt lgkmcnt(0)
    v_add_u32 v11, v11, v126
    v_lshlrev_b32 v11, 4, v11
    ds_write_b128 v11, v[108:111] offset:56896
    s_mov_b64 exec, s[30:31]
    v_and_b32 v10, 31, v112
    v_lshlrev_b32 v10, 2, v10
    ds_bpermute_b32 v11, v10, v9
    v_add_u32 v7, 768, v0
    v_cmp_gt_u32 vcc, s45, v7
    s_and_saveexec_b64 s[30:31], vcc
    s_waitcnt lgkmcnt(0)
    v_add_u32 v11, v11, v127
    v_lshlrev_b32 v11, 4, v11
    ds_write_b128 v11, v[112:115] offset:56896
    s_mov_b64 exec, s[30:31]
    v_and_b32 v10, 31, v116
    v_lshlrev_b32 v10, 2, v10
    ds_bpermute_b32 v11, v10, v9
    v_add_u32 v7, 1024, v0
    v_cmp_gt_u32 vcc, s45, v7
    s_and_saveexec_b64 s[30:31], vcc
    s_waitcnt lgkmcnt(0)
    v_add_u32 v11, v11, v128
    v_lshlrev_b32 v11, 4, v11
    ds_write_b128 v11, v[116:119] offset:56896
    s_mov_b64 exec, s[30:31]
    v_and_b32 v10, 31, v120
    v_lshlrev_b32 v10, 2, v10
    ds_bpermute_b32 v11, v10, v9
    v_add_u32 v7, 1280, v0
    v_cmp_gt_u32 vcc, s45, v7
    s_and_saveexec_b64 s[30:31], vcc
    s_waitcnt lgkmcnt(0)
    v_add_u32 v11, v11, v129
    v_lshlrev_b32 v11, 4, v11
    ds_write_b128 v11, v[120:123] offset:56896
    s_mov_b64 exec, s[30:31]
    s_waitcnt lgkmcnt(0)
    s_barrier
    s_mul_i32 s48, s44, 5
    s_add_u32 s49, s48, 5
M_FIND0:
    s_cmp_ge_u32 s48, s49
    s_cbranch_scc1 M_WAVEDONE
    v_readlane_b32 s50, v9, s48
    s_add_u32 s47, s48, 1
    v_readlane_b32 s51, v9, s47
    s_nop 3
    s_cmp_lt_u32 s50, s51
    s_cbranch_scc1 M_FOUND0
    s_add_u32 s48, s48, 1
    s_branch M_FIND0
M_FOUND0:
    v_add_u32 v236, s50, v1
    v_cmp_gt_u32 s[40:41], s51, v236
    s_sub_u32 s52, s51, 1
    v_min_u32 v236, s52, v236
    v_lshlrev_b32 v236, 4, v236
    ds_read_b32 v237, v236 offset:56896
    v_add_u32 v238, s50, v2
    v_add_u32 v239, 0, v238
    v_min_u32 v239, s52, v239
    v_lshlrev_b32 v239, 4, v239
    ds_read_b64 v[240:241], v239 offset:56896
    ds_read_b64 v[208:209], v239 offset:56904
    v_add_u32 v239, 1, v238
    v_min_u32 v239, s52, v239
    v_lshlrev_b32 v239, 4, v239
    ds_read_b64 v[242:243], v239 offset:56896
    ds_read_b64 v[210:211], v239 offset:56904
    v_add_u32 v239, 2, v238
    v_min_u32 v239, s52, v239
    v_lshlrev_b32 v239, 4, v239
    ds_read_b64 v[244:245], v239 offset:56896
    ds_read_b64 v[212:213], v239 offset:56904
    v_add_u32 v239, 3, v238
    v_min_u32 v239, s52, v239
    v_lshlrev_b32 v239, 4, v239
    ds_read_b64 v[246:247], v239 offset:56896
    ds_read_b64 v[214:215], v239 offset:56904
    s_waitcnt lgkmcnt(0)
    v_lshrrev_b32 v237, 5, v237
    v_lshlrev_b32 v237, 5, v237
    v_add_u32 v237, v237, v3
    buffer_load_dwordx2 v[204:205], v237, s[8:11], 0 offen
    v_lshlrev_b32 v248, 9, v241
    v_add_u32 v248, v248, v4
    buffer_load_dwordx2 v[140:141], v248, s[4:7], 0 offen offset:0
    buffer_load_dwordx2 v[142:143], v248, s[4:7], 0 offen offset:128
    buffer_load_dwordx2 v[144:145], v248, s[4:7], 0 offen offset:256
    buffer_load_dwordx2 v[146:147], v248, s[4:7], 0 offen offset:384
    v_lshlrev_b32 v248, 9, v243
    v_add_u32 v249, v248, v4
    buffer_load_dwordx2 v[148:149], v249, s[4:7], 0 offen offset:0
    buffer_load_dwordx2 v[150:151], v249, s[4:7], 0 offen offset:128
    buffer_load_dwordx2 v[152:153], v249, s[4:7], 0 offen offset:256
    buffer_load_dwordx2 v[154:155], v249, s[4:7], 0 offen offset:384
    v_lshlrev_b32 v248, 9, v245
    v_add_u32 v250, v248, v4
    buffer_load_dwordx2 v[156:157], v250, s[4:7], 0 offen offset:0
    buffer_load_dwordx2 v[158:159], v250, s[4:7], 0 offen offset:128
    buffer_load_dwordx2 v[160:161], v250, s[4:7], 0 offen offset:256
    buffer_load_dwordx2 v[162:163], v250, s[4:7], 0 offen offset:384
    v_lshlrev_b32 v248, 9, v247
    v_add_u32 v251, v248, v4
    buffer_load_dwordx2 v[164:165], v251, s[4:7], 0 offen offset:0
    buffer_load_dwordx2 v[166:167], v251, s[4:7], 0 offen offset:128
    buffer_load_dwordx2 v[168:169], v251, s[4:7], 0 offen offset:256
    buffer_load_dwordx2 v[170:171], v251, s[4:7], 0 offen offset:384
    s_mov_b32 s57, s50
    s_mov_b32 s58, s51
    s_mov_b32 s59, s48
M_LOOP0:
    s_add_u32 s50, s57, 16
    s_mov_b32 s51, s58
    s_cmp_lt_u32 s50, s58
    s_cbranch_scc1 M_HASNEXT0
M_FIND0_N:
    s_add_u32 s48, s48, 1
    s_cmp_ge_u32 s48, s49
    s_cbranch_scc1 M_NONEXT0
    v_readlane_b32 s50, v9, s48
    s_add_u32 s47, s48, 1
    v_readlane_b32 s51, v9, s47
    s_nop 3
    s_cmp_lt_u32 s50, s51
    s_cbranch_scc0 M_FIND0_N
M_HASNEXT0:
    v_add_u32 v236, s50, v1
    v_cmp_gt_u32 s[42:43], s51, v236
    s_sub_u32 s52, s51, 1
    v_min_u32 v236, s52, v236
    v_lshlrev_b32 v236, 4, v236
    ds_read_b32 v237, v236 offset:56896
    v_add_u32 v238, s50, v2
    v_add_u32 v239, 0, v238
    v_min_u32 v239, s52, v239
    v_lshlrev_b32 v239, 4, v239
    ds_read_b64 v[240:241], v239 offset:56896
    ds_read_b64 v[216:217], v239 offset:56904
    v_add_u32 v239, 1, v238
    v_min_u32 v239, s52, v239
    v_lshlrev_b32 v239, 4, v239
    ds_read_b64 v[242:243], v239 offset:56896
    ds_read_b64 v[218:219], v239 offset:56904
    v_add_u32 v239, 2, v238
    v_min_u32 v239, s52, v239
    v_lshlrev_b32 v239, 4, v239
    ds_read_b64 v[244:245], v239 offset:56896
    ds_read_b64 v[220:221], v239 offset:56904
    v_add_u32 v239, 3, v238
    v_min_u32 v239, s52, v239
    v_lshlrev_b32 v239, 4, v239
    ds_read_b64 v[246:247], v239 offset:56896
    ds_read_b64 v[222:223], v239 offset:56904
    s_waitcnt lgkmcnt(0)
    v_lshrrev_b32 v237, 5, v237
    v_lshlrev_b32 v237, 5, v237
    v_add_u32 v237, v237, v3
    buffer_load_dwordx2 v[206:207], v237, s[8:11], 0 offen
    v_lshlrev_b32 v248, 9, v241
    v_add_u32 v248, v248, v4
    buffer_load_dwordx2 v[172:173], v248, s[4:7], 0 offen offset:0
    buffer_load_dwordx2 v[174:175], v248, s[4:7], 0 offen offset:128
    buffer_load_dwordx2 v[176:177], v248, s[4:7], 0 offen offset:256
    buffer_load_dwordx2 v[178:179], v248, s[4:7], 0 offen offset:384
    v_lshlrev_b32 v248, 9, v243
    v_add_u32 v249, v248, v4
    buffer_load_dwordx2 v[180:181], v249, s[4:7], 0 offen offset:0
    buffer_load_dwordx2 v[182:183], v249, s[4:7], 0 offen offset:128
    buffer_load_dwordx2 v[184:185], v249, s[4:7], 0 offen offset:256
    buffer_load_dwordx2 v[186:187], v249, s[4:7], 0 offen offset:384
    v_lshlrev_b32 v248, 9, v245
    v_add_u32 v250, v248, v4
    buffer_load_dwordx2 v[188:189], v250, s[4:7], 0 offen offset:0
    buffer_load_dwordx2 v[190:191], v250, s[4:7], 0 offen offset:128
    buffer_load_dwordx2 v[192:193], v250, s[4:7], 0 offen offset:256
    buffer_load_dwordx2 v[194:195], v250, s[4:7], 0 offen offset:384
    v_lshlrev_b32 v248, 9, v247
    v_add_u32 v251, v248, v4
    buffer_load_dwordx2 v[196:197], v251, s[4:7], 0 offen offset:0
    buffer_load_dwordx2 v[198:199], v251, s[4:7], 0 offen offset:128
    buffer_load_dwordx2 v[200:201], v251, s[4:7], 0 offen offset:256
    buffer_load_dwordx2 v[202:203], v251, s[4:7], 0 offen offset:384
    s_waitcnt vmcnt(17)
    s_mov_b32 s56, 1
    s_branch M_COMP0
M_NONEXT0:
    s_waitcnt vmcnt(0)
    s_mov_b32 s56, 0
M_COMP0:
    v_cndmask_b32 v204, 0, v204, s[40:41]
    v_cndmask_b32 v205, 0, v205, s[40:41]
    v_lshlrev_b32 v224, 16, v208
    v_and_b32 v225, 0xffff0000, v208
    v_lshlrev_b32 v226, 16, v209
    v_lshlrev_b32 v227, 16, v210
    v_and_b32 v228, 0xffff0000, v210
    v_lshlrev_b32 v229, 16, v211
    v_lshlrev_b32 v230, 16, v212
    v_and_b32 v231, 0xffff0000, v212
    v_lshlrev_b32 v232, 16, v213
    v_lshlrev_b32 v233, 16, v214
    v_and_b32 v234, 0xffff0000, v214
    v_lshlrev_b32 v235, 16, v215
    v_mfma_f32_16x16x16_bf16 v[100:103], v[204:205], v[16:17], 0
    v_mfma_f32_16x16x16_bf16 v[104:107], v[204:205], v[18:19], 0
    v_mfma_f32_16x16x16_bf16 v[108:111], v[204:205], v[24:25], 0
    v_mfma_f32_16x16x16_bf16 v[112:115], v[204:205], v[26:27], 0
    v_mfma_f32_16x16x16_bf16 v[116:119], v[204:205], v[32:33], 0
    v_mfma_f32_16x16x16_bf16 v[120:123], v[204:205], v[34:35], 0
    v_mfma_f32_16x16x16_bf16 v[124:127], v[204:205], v[40:41], 0
    v_mfma_f32_16x16x16_bf16 v[128:131], v[204:205], v[42:43], 0
    v_mfma_f32_16x16x16_bf16 v[132:135], v[204:205], v[48:49], 0
    v_mfma_f32_16x16x16_bf16 v[136:139], v[204:205], v[50:51], 0
    s_nop 7
    v_lshlrev_b32 v250, 16, v140
    v_lshlrev_b32 v251, 16, v142
    v_lshlrev_b32 v252, 16, v144
    v_lshlrev_b32 v253, 16, v146
    v_fmac_f32 v56, v250, v100
    v_mul_f32 v254, v251, v224
    v_fmac_f32 v254, v252, v225
    v_fmac_f32 v254, v253, v226
    v_fmac_f32 v60, v254, v108
    v_mul_f32 v255, v250, v116
    v_fmac_f32 v64, v255, v224
    v_fmac_f32 v68, v255, v225
    v_fmac_f32 v72, v255, v226
    v_fmac_f32 v76, v251, v124
    v_fmac_f32 v80, v252, v124
    v_fmac_f32 v84, v253, v124
    v_mul_f32 v254, v253, v225
    v_fma_f32 v254, -v252, v226, v254
    v_fmac_f32 v88, v254, v132
    v_mul_f32 v254, v251, v226
    v_fma_f32 v254, -v253, v224, v254
    v_fmac_f32 v92, v254, v132
    v_mul_f32 v254, v252, v224
    v_fma_f32 v254, -v251, v225, v254
    v_fmac_f32 v96, v254, v132
    v_and_b32 v250, 0xffff0000, v140
    v_and_b32 v251, 0xffff0000, v142
    v_and_b32 v252, 0xffff0000, v144
    v_and_b32 v253, 0xffff0000, v146
    v_fmac_f32 v57, v250, v104
    v_mul_f32 v254, v251, v224
    v_fmac_f32 v254, v252, v225
    v_fmac_f32 v254, v253, v226
    v_fmac_f32 v61, v254, v112
    v_mul_f32 v255, v250, v120
    v_fmac_f32 v65, v255, v224
    v_fmac_f32 v69, v255, v225
    v_fmac_f32 v73, v255, v226
    v_fmac_f32 v77, v251, v128
    v_fmac_f32 v81, v252, v128
    v_fmac_f32 v85, v253, v128
    v_mul_f32 v254, v253, v225
    v_fma_f32 v254, -v252, v226, v254
    v_fmac_f32 v89, v254, v136
    v_mul_f32 v254, v251, v226
    v_fma_f32 v254, -v253, v224, v254
    v_fmac_f32 v93, v254, v136
    v_mul_f32 v254, v252, v224
    v_fma_f32 v254, -v251, v225, v254
    v_fmac_f32 v97, v254, v136
    v_lshlrev_b32 v250, 16, v148
    v_lshlrev_b32 v251, 16, v150
    v_lshlrev_b32 v252, 16, v152
    v_lshlrev_b32 v253, 16, v154
    v_fmac_f32 v56, v250, v101
    v_mul_f32 v254, v251, v227
    v_fmac_f32 v254, v252, v228
    v_fmac_f32 v254, v253, v229
    v_fmac_f32 v60, v254, v109
    v_mul_f32 v255, v250, v117
    v_fmac_f32 v64, v255, v227
    v_fmac_f32 v68, v255, v228
    v_fmac_f32 v72, v255, v229
    v_fmac_f32 v76, v251, v125
    v_fmac_f32 v80, v252, v125
    v_fmac_f32 v84, v253, v125
    v_mul_f32 v254, v253, v228
    v_fma_f32 v254, -v252, v229, v254
    v_fmac_f32 v88, v254, v133
    v_mul_f32 v254, v251, v229
    v_fma_f32 v254, -v253, v227, v254
    v_fmac_f32 v92, v254, v133
    v_mul_f32 v254, v252, v227
    v_fma_f32 v254, -v251, v228, v254
    v_fmac_f32 v96, v254, v133
    v_and_b32 v250, 0xffff0000, v148
    v_and_b32 v251, 0xffff0000, v150
    v_and_b32 v252, 0xffff0000, v152
    v_and_b32 v253, 0xffff0000, v154
    v_fmac_f32 v57, v250, v105
    v_mul_f32 v254, v251, v227
    v_fmac_f32 v254, v252, v228
    v_fmac_f32 v254, v253, v229
    v_fmac_f32 v61, v254, v113
    v_mul_f32 v255, v250, v121
    v_fmac_f32 v65, v255, v227
    v_fmac_f32 v69, v255, v228
    v_fmac_f32 v73, v255, v229
    v_fmac_f32 v77, v251, v129
    v_fmac_f32 v81, v252, v129
    v_fmac_f32 v85, v253, v129
    v_mul_f32 v254, v253, v228
    v_fma_f32 v254, -v252, v229, v254
    v_fmac_f32 v89, v254, v137
    v_mul_f32 v254, v251, v229
    v_fma_f32 v254, -v253, v227, v254
    v_fmac_f32 v93, v254, v137
    v_mul_f32 v254, v252, v227
    v_fma_f32 v254, -v251, v228, v254
    v_fmac_f32 v97, v254, v137
    v_lshlrev_b32 v250, 16, v156
    v_lshlrev_b32 v251, 16, v158
    v_lshlrev_b32 v252, 16, v160
    v_lshlrev_b32 v253, 16, v162
    v_fmac_f32 v56, v250, v102
    v_mul_f32 v254, v251, v230
    v_fmac_f32 v254, v252, v231
    v_fmac_f32 v254, v253, v232
    v_fmac_f32 v60, v254, v110
    v_mul_f32 v255, v250, v118
    v_fmac_f32 v64, v255, v230
    v_fmac_f32 v68, v255, v231
    v_fmac_f32 v72, v255, v232
    v_fmac_f32 v76, v251, v126
    v_fmac_f32 v80, v252, v126
    v_fmac_f32 v84, v253, v126
    v_mul_f32 v254, v253, v231
    v_fma_f32 v254, -v252, v232, v254
    v_fmac_f32 v88, v254, v134
    v_mul_f32 v254, v251, v232
    v_fma_f32 v254, -v253, v230, v254
    v_fmac_f32 v92, v254, v134
    v_mul_f32 v254, v252, v230
    v_fma_f32 v254, -v251, v231, v254
    v_fmac_f32 v96, v254, v134
    v_and_b32 v250, 0xffff0000, v156
    v_and_b32 v251, 0xffff0000, v158
    v_and_b32 v252, 0xffff0000, v160
    v_and_b32 v253, 0xffff0000, v162
    v_fmac_f32 v57, v250, v106
    v_mul_f32 v254, v251, v230
    v_fmac_f32 v254, v252, v231
    v_fmac_f32 v254, v253, v232
    v_fmac_f32 v61, v254, v114
    v_mul_f32 v255, v250, v122
    v_fmac_f32 v65, v255, v230
    v_fmac_f32 v69, v255, v231
    v_fmac_f32 v73, v255, v232
    v_fmac_f32 v77, v251, v130
    v_fmac_f32 v81, v252, v130
    v_fmac_f32 v85, v253, v130
    v_mul_f32 v254, v253, v231
    v_fma_f32 v254, -v252, v232, v254
    v_fmac_f32 v89, v254, v138
    v_mul_f32 v254, v251, v232
    v_fma_f32 v254, -v253, v230, v254
    v_fmac_f32 v93, v254, v138
    v_mul_f32 v254, v252, v230
    v_fma_f32 v254, -v251, v231, v254
    v_fmac_f32 v97, v254, v138
    v_lshlrev_b32 v250, 16, v164
    v_lshlrev_b32 v251, 16, v166
    v_lshlrev_b32 v252, 16, v168
    v_lshlrev_b32 v253, 16, v170
    v_fmac_f32 v56, v250, v103
    v_mul_f32 v254, v251, v233
    v_fmac_f32 v254, v252, v234
    v_fmac_f32 v254, v253, v235
    v_fmac_f32 v60, v254, v111
    v_mul_f32 v255, v250, v119
    v_fmac_f32 v64, v255, v233
    v_fmac_f32 v68, v255, v234
    v_fmac_f32 v72, v255, v235
    v_fmac_f32 v76, v251, v127
    v_fmac_f32 v80, v252, v127
    v_fmac_f32 v84, v253, v127
    v_mul_f32 v254, v253, v234
    v_fma_f32 v254, -v252, v235, v254
    v_fmac_f32 v88, v254, v135
    v_mul_f32 v254, v251, v235
    v_fma_f32 v254, -v253, v233, v254
    v_fmac_f32 v92, v254, v135
    v_mul_f32 v254, v252, v233
    v_fma_f32 v254, -v251, v234, v254
    v_fmac_f32 v96, v254, v135
    v_and_b32 v250, 0xffff0000, v164
    v_and_b32 v251, 0xffff0000, v166
    v_and_b32 v252, 0xffff0000, v168
    v_and_b32 v253, 0xffff0000, v170
    v_fmac_f32 v57, v250, v107
    v_mul_f32 v254, v251, v233
    v_fmac_f32 v254, v252, v234
    v_fmac_f32 v254, v253, v235
    v_fmac_f32 v61, v254, v115
    v_mul_f32 v255, v250, v123
    v_fmac_f32 v65, v255, v233
    v_fmac_f32 v69, v255, v234
    v_fmac_f32 v73, v255, v235
    v_fmac_f32 v77, v251, v131
    v_fmac_f32 v81, v252, v131
    v_fmac_f32 v85, v253, v131
    v_mul_f32 v254, v253, v234
    v_fma_f32 v254, -v252, v235, v254
    v_fmac_f32 v89, v254, v139
    v_mul_f32 v254, v251, v235
    v_fma_f32 v254, -v253, v233, v254
    v_fmac_f32 v93, v254, v139
    v_mul_f32 v254, v252, v233
    v_fma_f32 v254, -v251, v234, v254
    v_fmac_f32 v97, v254, v139
    v_mfma_f32_16x16x16_bf16 v[100:103], v[204:205], v[20:21], 0
    v_mfma_f32_16x16x16_bf16 v[104:107], v[204:205], v[22:23], 0
    v_mfma_f32_16x16x16_bf16 v[108:111], v[204:205], v[28:29], 0
    v_mfma_f32_16x16x16_bf16 v[112:115], v[204:205], v[30:31], 0
    v_mfma_f32_16x16x16_bf16 v[116:119], v[204:205], v[36:37], 0
    v_mfma_f32_16x16x16_bf16 v[120:123], v[204:205], v[38:39], 0
    v_mfma_f32_16x16x16_bf16 v[124:127], v[204:205], v[44:45], 0
    v_mfma_f32_16x16x16_bf16 v[128:131], v[204:205], v[46:47], 0
    v_mfma_f32_16x16x16_bf16 v[132:135], v[204:205], v[52:53], 0
    v_mfma_f32_16x16x16_bf16 v[136:139], v[204:205], v[54:55], 0
    s_nop 7
    v_lshlrev_b32 v250, 16, v141
    v_lshlrev_b32 v251, 16, v143
    v_lshlrev_b32 v252, 16, v145
    v_lshlrev_b32 v253, 16, v147
    v_fmac_f32 v58, v250, v100
    v_mul_f32 v254, v251, v224
    v_fmac_f32 v254, v252, v225
    v_fmac_f32 v254, v253, v226
    v_fmac_f32 v62, v254, v108
    v_mul_f32 v255, v250, v116
    v_fmac_f32 v66, v255, v224
    v_fmac_f32 v70, v255, v225
    v_fmac_f32 v74, v255, v226
    v_fmac_f32 v78, v251, v124
    v_fmac_f32 v82, v252, v124
    v_fmac_f32 v86, v253, v124
    v_mul_f32 v254, v253, v225
    v_fma_f32 v254, -v252, v226, v254
    v_fmac_f32 v90, v254, v132
    v_mul_f32 v254, v251, v226
    v_fma_f32 v254, -v253, v224, v254
    v_fmac_f32 v94, v254, v132
    v_mul_f32 v254, v252, v224
    v_fma_f32 v254, -v251, v225, v254
    v_fmac_f32 v98, v254, v132
    v_and_b32 v250, 0xffff0000, v141
    v_and_b32 v251, 0xffff0000, v143
    v_and_b32 v252, 0xffff0000, v145
    v_and_b32 v253, 0xffff0000, v147
    v_fmac_f32 v59, v250, v104
    v_mul_f32 v254, v251, v224
    v_fmac_f32 v254, v252, v225
    v_fmac_f32 v254, v253, v226
    v_fmac_f32 v63, v254, v112
    v_mul_f32 v255, v250, v120
    v_fmac_f32 v67, v255, v224
    v_fmac_f32 v71, v255, v225
    v_fmac_f32 v75, v255, v226
    v_fmac_f32 v79, v251, v128
    v_fmac_f32 v83, v252, v128
    v_fmac_f32 v87, v253, v128
    v_mul_f32 v254, v253, v225
    v_fma_f32 v254, -v252, v226, v254
    v_fmac_f32 v91, v254, v136
    v_mul_f32 v254, v251, v226
    v_fma_f32 v254, -v253, v224, v254
    v_fmac_f32 v95, v254, v136
    v_mul_f32 v254, v252, v224
    v_fma_f32 v254, -v251, v225, v254
    v_fmac_f32 v99, v254, v136
    v_lshlrev_b32 v250, 16, v149
    v_lshlrev_b32 v251, 16, v151
    v_lshlrev_b32 v252, 16, v153
    v_lshlrev_b32 v253, 16, v155
    v_fmac_f32 v58, v250, v101
    v_mul_f32 v254, v251, v227
    v_fmac_f32 v254, v252, v228
    v_fmac_f32 v254, v253, v229
    v_fmac_f32 v62, v254, v109
    v_mul_f32 v255, v250, v117
    v_fmac_f32 v66, v255, v227
    v_fmac_f32 v70, v255, v228
    v_fmac_f32 v74, v255, v229
    v_fmac_f32 v78, v251, v125
    v_fmac_f32 v82, v252, v125
    v_fmac_f32 v86, v253, v125
    v_mul_f32 v254, v253, v228
    v_fma_f32 v254, -v252, v229, v254
    v_fmac_f32 v90, v254, v133
    v_mul_f32 v254, v251, v229
    v_fma_f32 v254, -v253, v227, v254
    v_fmac_f32 v94, v254, v133
    v_mul_f32 v254, v252, v227
    v_fma_f32 v254, -v251, v228, v254
    v_fmac_f32 v98, v254, v133
    v_and_b32 v250, 0xffff0000, v149
    v_and_b32 v251, 0xffff0000, v151
    v_and_b32 v252, 0xffff0000, v153
    v_and_b32 v253, 0xffff0000, v155
    v_fmac_f32 v59, v250, v105
    v_mul_f32 v254, v251, v227
    v_fmac_f32 v254, v252, v228
    v_fmac_f32 v254, v253, v229
    v_fmac_f32 v63, v254, v113
    v_mul_f32 v255, v250, v121
    v_fmac_f32 v67, v255, v227
    v_fmac_f32 v71, v255, v228
    v_fmac_f32 v75, v255, v229
    v_fmac_f32 v79, v251, v129
    v_fmac_f32 v83, v252, v129
    v_fmac_f32 v87, v253, v129
    v_mul_f32 v254, v253, v228
    v_fma_f32 v254, -v252, v229, v254
    v_fmac_f32 v91, v254, v137
    v_mul_f32 v254, v251, v229
    v_fma_f32 v254, -v253, v227, v254
    v_fmac_f32 v95, v254, v137
    v_mul_f32 v254, v252, v227
    v_fma_f32 v254, -v251, v228, v254
    v_fmac_f32 v99, v254, v137
    v_lshlrev_b32 v250, 16, v157
    v_lshlrev_b32 v251, 16, v159
    v_lshlrev_b32 v252, 16, v161
    v_lshlrev_b32 v253, 16, v163
    v_fmac_f32 v58, v250, v102
    v_mul_f32 v254, v251, v230
    v_fmac_f32 v254, v252, v231
    v_fmac_f32 v254, v253, v232
    v_fmac_f32 v62, v254, v110
    v_mul_f32 v255, v250, v118
    v_fmac_f32 v66, v255, v230
    v_fmac_f32 v70, v255, v231
    v_fmac_f32 v74, v255, v232
    v_fmac_f32 v78, v251, v126
    v_fmac_f32 v82, v252, v126
    v_fmac_f32 v86, v253, v126
    v_mul_f32 v254, v253, v231
    v_fma_f32 v254, -v252, v232, v254
    v_fmac_f32 v90, v254, v134
    v_mul_f32 v254, v251, v232
    v_fma_f32 v254, -v253, v230, v254
    v_fmac_f32 v94, v254, v134
    v_mul_f32 v254, v252, v230
    v_fma_f32 v254, -v251, v231, v254
    v_fmac_f32 v98, v254, v134
    v_and_b32 v250, 0xffff0000, v157
    v_and_b32 v251, 0xffff0000, v159
    v_and_b32 v252, 0xffff0000, v161
    v_and_b32 v253, 0xffff0000, v163
    v_fmac_f32 v59, v250, v106
    v_mul_f32 v254, v251, v230
    v_fmac_f32 v254, v252, v231
    v_fmac_f32 v254, v253, v232
    v_fmac_f32 v63, v254, v114
    v_mul_f32 v255, v250, v122
    v_fmac_f32 v67, v255, v230
    v_fmac_f32 v71, v255, v231
    v_fmac_f32 v75, v255, v232
    v_fmac_f32 v79, v251, v130
    v_fmac_f32 v83, v252, v130
    v_fmac_f32 v87, v253, v130
    v_mul_f32 v254, v253, v231
    v_fma_f32 v254, -v252, v232, v254
    v_fmac_f32 v91, v254, v138
    v_mul_f32 v254, v251, v232
    v_fma_f32 v254, -v253, v230, v254
    v_fmac_f32 v95, v254, v138
    v_mul_f32 v254, v252, v230
    v_fma_f32 v254, -v251, v231, v254
    v_fmac_f32 v99, v254, v138
    v_lshlrev_b32 v250, 16, v165
    v_lshlrev_b32 v251, 16, v167
    v_lshlrev_b32 v252, 16, v169
    v_lshlrev_b32 v253, 16, v171
    v_fmac_f32 v58, v250, v103
    v_mul_f32 v254, v251, v233
    v_fmac_f32 v254, v252, v234
    v_fmac_f32 v254, v253, v235
    v_fmac_f32 v62, v254, v111
    v_mul_f32 v255, v250, v119
    v_fmac_f32 v66, v255, v233
    v_fmac_f32 v70, v255, v234
    v_fmac_f32 v74, v255, v235
    v_fmac_f32 v78, v251, v127
    v_fmac_f32 v82, v252, v127
    v_fmac_f32 v86, v253, v127
    v_mul_f32 v254, v253, v234
    v_fma_f32 v254, -v252, v235, v254
    v_fmac_f32 v90, v254, v135
    v_mul_f32 v254, v251, v235
    v_fma_f32 v254, -v253, v233, v254
    v_fmac_f32 v94, v254, v135
    v_mul_f32 v254, v252, v233
    v_fma_f32 v254, -v251, v234, v254
    v_fmac_f32 v98, v254, v135
    v_and_b32 v250, 0xffff0000, v165
    v_and_b32 v251, 0xffff0000, v167
    v_and_b32 v252, 0xffff0000, v169
    v_and_b32 v253, 0xffff0000, v171
    v_fmac_f32 v59, v250, v107
    v_mul_f32 v254, v251, v233
    v_fmac_f32 v254, v252, v234
    v_fmac_f32 v254, v253, v235
    v_fmac_f32 v63, v254, v115
    v_mul_f32 v255, v250, v123
    v_fmac_f32 v67, v255, v233
    v_fmac_f32 v71, v255, v234
    v_fmac_f32 v75, v255, v235
    v_fmac_f32 v79, v251, v131
    v_fmac_f32 v83, v252, v131
    v_fmac_f32 v87, v253, v131
    v_mul_f32 v254, v253, v234
    v_fma_f32 v254, -v252, v235, v254
    v_fmac_f32 v91, v254, v139
    v_mul_f32 v254, v251, v235
    v_fma_f32 v254, -v253, v233, v254
    v_fmac_f32 v95, v254, v139
    v_mul_f32 v254, v252, v233
    v_fma_f32 v254, -v251, v234, v254
    v_fmac_f32 v99, v254, v139
    s_add_u32 s47, s57, 16
    s_cmp_lt_u32 s47, s58
    s_cbranch_scc1 M_NOFLUSH0
    s_mov_b32 s53, s59
    v_mov_b32 v237, v56
    v_mov_b32 v238, v57
    v_mov_b32 v239, v58
    v_mov_b32 v240, v59
    s_nop 0
    v_permlane32_swap_b32 v56, v237
    v_permlane32_swap_b32 v57, v238
    v_permlane32_swap_b32 v58, v239
    v_permlane32_swap_b32 v59, v240
    v_add_f32 v56, v56, v237
    v_add_f32 v57, v57, v238
    v_add_f32 v58, v58, v239
    v_add_f32 v59, v59, v240
    v_mov_b32 v237, v56
    v_mov_b32 v238, v57
    v_mov_b32 v239, v58
    v_mov_b32 v240, v59
    s_nop 0
    v_permlane16_swap_b32 v56, v237
    v_permlane16_swap_b32 v57, v238
    v_permlane16_swap_b32 v58, v239
    v_permlane16_swap_b32 v59, v240
    v_add_f32 v56, v56, v237
    v_add_f32 v57, v57, v238
    v_add_f32 v58, v58, v239
    v_add_f32 v59, v59, v240
    v_mov_b32 v237, v60
    v_mov_b32 v238, v61
    v_mov_b32 v239, v62
    v_mov_b32 v240, v63
    s_nop 0
    v_permlane32_swap_b32 v60, v237
    v_permlane32_swap_b32 v61, v238
    v_permlane32_swap_b32 v62, v239
    v_permlane32_swap_b32 v63, v240
    v_add_f32 v60, v60, v237
    v_add_f32 v61, v61, v238
    v_add_f32 v62, v62, v239
    v_add_f32 v63, v63, v240
    v_mov_b32 v237, v60
    v_mov_b32 v238, v61
    v_mov_b32 v239, v62
    v_mov_b32 v240, v63
    s_nop 0
    v_permlane16_swap_b32 v60, v237
    v_permlane16_swap_b32 v61, v238
    v_permlane16_swap_b32 v62, v239
    v_permlane16_swap_b32 v63, v240
    v_add_f32 v60, v60, v237
    v_add_f32 v61, v61, v238
    v_add_f32 v62, v62, v239
    v_add_f32 v63, v63, v240
    v_mov_b32 v237, v64
    v_mov_b32 v238, v65
    v_mov_b32 v239, v66
    v_mov_b32 v240, v67
    s_nop 0
    v_permlane32_swap_b32 v64, v237
    v_permlane32_swap_b32 v65, v238
    v_permlane32_swap_b32 v66, v239
    v_permlane32_swap_b32 v67, v240
    v_add_f32 v64, v64, v237
    v_add_f32 v65, v65, v238
    v_add_f32 v66, v66, v239
    v_add_f32 v67, v67, v240
    v_mov_b32 v237, v64
    v_mov_b32 v238, v65
    v_mov_b32 v239, v66
    v_mov_b32 v240, v67
    s_nop 0
    v_permlane16_swap_b32 v64, v237
    v_permlane16_swap_b32 v65, v238
    v_permlane16_swap_b32 v66, v239
    v_permlane16_swap_b32 v67, v240
    v_add_f32 v64, v64, v237
    v_add_f32 v65, v65, v238
    v_add_f32 v66, v66, v239
    v_add_f32 v67, v67, v240
    v_mov_b32 v237, v68
    v_mov_b32 v238, v69
    v_mov_b32 v239, v70
    v_mov_b32 v240, v71
    s_nop 0
    v_permlane32_swap_b32 v68, v237
    v_permlane32_swap_b32 v69, v238
    v_permlane32_swap_b32 v70, v239
    v_permlane32_swap_b32 v71, v240
    v_add_f32 v68, v68, v237
    v_add_f32 v69, v69, v238
    v_add_f32 v70, v70, v239
    v_add_f32 v71, v71, v240
    v_mov_b32 v237, v68
    v_mov_b32 v238, v69
    v_mov_b32 v239, v70
    v_mov_b32 v240, v71
    s_nop 0
    v_permlane16_swap_b32 v68, v237
    v_permlane16_swap_b32 v69, v238
    v_permlane16_swap_b32 v70, v239
    v_permlane16_swap_b32 v71, v240
    v_add_f32 v68, v68, v237
    v_add_f32 v69, v69, v238
    v_add_f32 v70, v70, v239
    v_add_f32 v71, v71, v240
    v_mov_b32 v237, v72
    v_mov_b32 v238, v73
    v_mov_b32 v239, v74
    v_mov_b32 v240, v75
    s_nop 0
    v_permlane32_swap_b32 v72, v237
    v_permlane32_swap_b32 v73, v238
    v_permlane32_swap_b32 v74, v239
    v_permlane32_swap_b32 v75, v240
    v_add_f32 v72, v72, v237
    v_add_f32 v73, v73, v238
    v_add_f32 v74, v74, v239
    v_add_f32 v75, v75, v240
    v_mov_b32 v237, v72
    v_mov_b32 v238, v73
    v_mov_b32 v239, v74
    v_mov_b32 v240, v75
    s_nop 0
    v_permlane16_swap_b32 v72, v237
    v_permlane16_swap_b32 v73, v238
    v_permlane16_swap_b32 v74, v239
    v_permlane16_swap_b32 v75, v240
    v_add_f32 v72, v72, v237
    v_add_f32 v73, v73, v238
    v_add_f32 v74, v74, v239
    v_add_f32 v75, v75, v240
    v_mov_b32 v237, v76
    v_mov_b32 v238, v77
    v_mov_b32 v239, v78
    v_mov_b32 v240, v79
    s_nop 0
    v_permlane32_swap_b32 v76, v237
    v_permlane32_swap_b32 v77, v238
    v_permlane32_swap_b32 v78, v239
    v_permlane32_swap_b32 v79, v240
    v_add_f32 v76, v76, v237
    v_add_f32 v77, v77, v238
    v_add_f32 v78, v78, v239
    v_add_f32 v79, v79, v240
    v_mov_b32 v237, v76
    v_mov_b32 v238, v77
    v_mov_b32 v239, v78
    v_mov_b32 v240, v79
    s_nop 0
    v_permlane16_swap_b32 v76, v237
    v_permlane16_swap_b32 v77, v238
    v_permlane16_swap_b32 v78, v239
    v_permlane16_swap_b32 v79, v240
    v_add_f32 v76, v76, v237
    v_add_f32 v77, v77, v238
    v_add_f32 v78, v78, v239
    v_add_f32 v79, v79, v240
    v_mov_b32 v237, v80
    v_mov_b32 v238, v81
    v_mov_b32 v239, v82
    v_mov_b32 v240, v83
    s_nop 0
    v_permlane32_swap_b32 v80, v237
    v_permlane32_swap_b32 v81, v238
    v_permlane32_swap_b32 v82, v239
    v_permlane32_swap_b32 v83, v240
    v_add_f32 v80, v80, v237
    v_add_f32 v81, v81, v238
    v_add_f32 v82, v82, v239
    v_add_f32 v83, v83, v240
    v_mov_b32 v237, v80
    v_mov_b32 v238, v81
    v_mov_b32 v239, v82
    v_mov_b32 v240, v83
    s_nop 0
    v_permlane16_swap_b32 v80, v237
    v_permlane16_swap_b32 v81, v238
    v_permlane16_swap_b32 v82, v239
    v_permlane16_swap_b32 v83, v240
    v_add_f32 v80, v80, v237
    v_add_f32 v81, v81, v238
    v_add_f32 v82, v82, v239
    v_add_f32 v83, v83, v240
    v_mov_b32 v237, v84
    v_mov_b32 v238, v85
    v_mov_b32 v239, v86
    v_mov_b32 v240, v87
    s_nop 0
    v_permlane32_swap_b32 v84, v237
    v_permlane32_swap_b32 v85, v238
    v_permlane32_swap_b32 v86, v239
    v_permlane32_swap_b32 v87, v240
    v_add_f32 v84, v84, v237
    v_add_f32 v85, v85, v238
    v_add_f32 v86, v86, v239
    v_add_f32 v87, v87, v240
    v_mov_b32 v237, v84
    v_mov_b32 v238, v85
    v_mov_b32 v239, v86
    v_mov_b32 v240, v87
    s_nop 0
    v_permlane16_swap_b32 v84, v237
    v_permlane16_swap_b32 v85, v238
    v_permlane16_swap_b32 v86, v239
    v_permlane16_swap_b32 v87, v240
    v_add_f32 v84, v84, v237
    v_add_f32 v85, v85, v238
    v_add_f32 v86, v86, v239
    v_add_f32 v87, v87, v240
    v_mov_b32 v237, v88
    v_mov_b32 v238, v89
    v_mov_b32 v239, v90
    v_mov_b32 v240, v91
    s_nop 0
    v_permlane32_swap_b32 v88, v237
    v_permlane32_swap_b32 v89, v238
    v_permlane32_swap_b32 v90, v239
    v_permlane32_swap_b32 v91, v240
    v_add_f32 v88, v88, v237
    v_add_f32 v89, v89, v238
    v_add_f32 v90, v90, v239
    v_add_f32 v91, v91, v240
    v_mov_b32 v237, v88
    v_mov_b32 v238, v89
    v_mov_b32 v239, v90
    v_mov_b32 v240, v91
    s_nop 0
    v_permlane16_swap_b32 v88, v237
    v_permlane16_swap_b32 v89, v238
    v_permlane16_swap_b32 v90, v239
    v_permlane16_swap_b32 v91, v240
    v_add_f32 v88, v88, v237
    v_add_f32 v89, v89, v238
    v_add_f32 v90, v90, v239
    v_add_f32 v91, v91, v240
    v_mov_b32 v237, v92
    v_mov_b32 v238, v93
    v_mov_b32 v239, v94
    v_mov_b32 v240, v95
    s_nop 0
    v_permlane32_swap_b32 v92, v237
    v_permlane32_swap_b32 v93, v238
    v_permlane32_swap_b32 v94, v239
    v_permlane32_swap_b32 v95, v240
    v_add_f32 v92, v92, v237
    v_add_f32 v93, v93, v238
    v_add_f32 v94, v94, v239
    v_add_f32 v95, v95, v240
    v_mov_b32 v237, v92
    v_mov_b32 v238, v93
    v_mov_b32 v239, v94
    v_mov_b32 v240, v95
    s_nop 0
    v_permlane16_swap_b32 v92, v237
    v_permlane16_swap_b32 v93, v238
    v_permlane16_swap_b32 v94, v239
    v_permlane16_swap_b32 v95, v240
    v_add_f32 v92, v92, v237
    v_add_f32 v93, v93, v238
    v_add_f32 v94, v94, v239
    v_add_f32 v95, v95, v240
    v_mov_b32 v237, v96
    v_mov_b32 v238, v97
    v_mov_b32 v239, v98
    v_mov_b32 v240, v99
    s_nop 0
    v_permlane32_swap_b32 v96, v237
    v_permlane32_swap_b32 v97, v238
    v_permlane32_swap_b32 v98, v239
    v_permlane32_swap_b32 v99, v240
    v_add_f32 v96, v96, v237
    v_add_f32 v97, v97, v238
    v_add_f32 v98, v98, v239
    v_add_f32 v99, v99, v240
    v_mov_b32 v237, v96
    v_mov_b32 v238, v97
    v_mov_b32 v239, v98
    v_mov_b32 v240, v99
    s_nop 0
    v_permlane16_swap_b32 v96, v237
    v_permlane16_swap_b32 v97, v238
    v_permlane16_swap_b32 v98, v239
    v_permlane16_swap_b32 v99, v240
    v_add_f32 v96, v96, v237
    v_add_f32 v97, v97, v238
    v_add_f32 v98, v98, v239
    v_add_f32 v99, v99, v240
    s_mul_i32 s54, s53, 2832
    v_add_u32 v236, s54, v5
    s_mov_b64 exec, 0xffff
    ds_read_b128 v[100:103], v236 offset:256
    ds_read_b128 v[104:107], v236 offset:512
    ds_read_b128 v[108:111], v236 offset:768
    ds_read_b128 v[112:115], v236 offset:1536
    ds_read_b128 v[116:119], v236 offset:2304
    ds_read_b128 v[120:123], v236 offset:1024
    ds_read_b128 v[124:127], v236 offset:1792
    ds_read_b128 v[128:131], v236 offset:2560
    ds_read_b128 v[132:135], v236 offset:1280
    ds_read_b128 v[136:139], v236 offset:2048
    s_waitcnt lgkmcnt(0)
    v_add_f32 v56, v56, v100
    v_add_f32 v57, v57, v101
    v_add_f32 v58, v58, v102
    v_add_f32 v59, v59, v103
    v_add_f32 v60, v60, v104
    v_add_f32 v61, v61, v105
    v_add_f32 v62, v62, v106
    v_add_f32 v63, v63, v107
    v_add_f32 v64, v64, v108
    v_add_f32 v65, v65, v109
    v_add_f32 v66, v66, v110
    v_add_f32 v67, v67, v111
    v_add_f32 v68, v68, v112
    v_add_f32 v69, v69, v113
    v_add_f32 v70, v70, v114
    v_add_f32 v71, v71, v115
    v_add_f32 v72, v72, v116
    v_add_f32 v73, v73, v117
    v_add_f32 v74, v74, v118
    v_add_f32 v75, v75, v119
    v_add_f32 v76, v76, v120
    v_add_f32 v77, v77, v121
    v_add_f32 v78, v78, v122
    v_add_f32 v79, v79, v123
    v_add_f32 v80, v80, v124
    v_add_f32 v81, v81, v125
    v_add_f32 v82, v82, v126
    v_add_f32 v83, v83, v127
    v_add_f32 v84, v84, v128
    v_add_f32 v85, v85, v129
    v_add_f32 v86, v86, v130
    v_add_f32 v87, v87, v131
    v_add_f32 v88, v88, v132
    v_add_f32 v89, v89, v133
    v_add_f32 v90, v90, v134
    v_add_f32 v91, v91, v135
    v_add_f32 v92, v92, v136
    v_add_f32 v93, v93, v137
    v_add_f32 v94, v94, v138
    v_add_f32 v95, v95, v139
    ds_read_b128 v[100:103], v236 offset:2816
    s_waitcnt lgkmcnt(0)
    v_add_f32 v96, v96, v100
    v_add_f32 v97, v97, v101
    v_add_f32 v98, v98, v102
    v_add_f32 v99, v99, v103
    ds_write_b128 v236, v[56:59] offset:256
    ds_write_b128 v236, v[60:63] offset:512
    ds_write_b128 v236, v[64:67] offset:768
    ds_write_b128 v236, v[68:71] offset:1536
    ds_write_b128 v236, v[72:75] offset:2304
    ds_write_b128 v236, v[76:79] offset:1024
    ds_write_b128 v236, v[80:83] offset:1792
    ds_write_b128 v236, v[84:87] offset:2560
    ds_write_b128 v236, v[88:91] offset:1280
    ds_write_b128 v236, v[92:95] offset:2048
    ds_write_b128 v236, v[96:99] offset:2816
    s_mov_b64 exec, -1
    s_waitcnt lgkmcnt(0)
    v_mov_b32 v56, 0
    v_mov_b32 v57, 0
    v_mov_b32 v58, 0
    v_mov_b32 v59, 0
    v_mov_b32 v60, 0
    v_mov_b32 v61, 0
    v_mov_b32 v62, 0
    v_mov_b32 v63, 0
    v_mov_b32 v64, 0
    v_mov_b32 v65, 0
    v_mov_b32 v66, 0
    v_mov_b32 v67, 0
    v_mov_b32 v68, 0
    v_mov_b32 v69, 0
    v_mov_b32 v70, 0
    v_mov_b32 v71, 0
    v_mov_b32 v72, 0
    v_mov_b32 v73, 0
    v_mov_b32 v74, 0
    v_mov_b32 v75, 0
    v_mov_b32 v76, 0
    v_mov_b32 v77, 0
    v_mov_b32 v78, 0
    v_mov_b32 v79, 0
    v_mov_b32 v80, 0
    v_mov_b32 v81, 0
    v_mov_b32 v82, 0
    v_mov_b32 v83, 0
    v_mov_b32 v84, 0
    v_mov_b32 v85, 0
    v_mov_b32 v86, 0
    v_mov_b32 v87, 0
    v_mov_b32 v88, 0
    v_mov_b32 v89, 0
    v_mov_b32 v90, 0
    v_mov_b32 v91, 0
    v_mov_b32 v92, 0
    v_mov_b32 v93, 0
    v_mov_b32 v94, 0
    v_mov_b32 v95, 0
    v_mov_b32 v96, 0
    v_mov_b32 v97, 0
    v_mov_b32 v98, 0
    v_mov_b32 v99, 0
M_NOFLUSH0:
    s_cmp_eq_u32 s56, 0
    s_cbranch_scc1 M_WAVEDONE
    s_mov_b32 s57, s50
    s_mov_b32 s58, s51
    s_mov_b32 s59, s48
M_LOOP1:
    s_add_u32 s50, s57, 16
    s_mov_b32 s51, s58
    s_cmp_lt_u32 s50, s58
    s_cbranch_scc1 M_HASNEXT1
M_FIND1_N:
    s_add_u32 s48, s48, 1
    s_cmp_ge_u32 s48, s49
    s_cbranch_scc1 M_NONEXT1
    v_readlane_b32 s50, v9, s48
    s_add_u32 s47, s48, 1
    v_readlane_b32 s51, v9, s47
    s_nop 3
    s_cmp_lt_u32 s50, s51
    s_cbranch_scc0 M_FIND1_N
M_HASNEXT1:
    v_add_u32 v236, s50, v1
    v_cmp_gt_u32 s[40:41], s51, v236
    s_sub_u32 s52, s51, 1
    v_min_u32 v236, s52, v236
    v_lshlrev_b32 v236, 4, v236
    ds_read_b32 v237, v236 offset:56896
    v_add_u32 v238, s50, v2
    v_add_u32 v239, 0, v238
    v_min_u32 v239, s52, v239
    v_lshlrev_b32 v239, 4, v239
    ds_read_b64 v[240:241], v239 offset:56896
    ds_read_b64 v[208:209], v239 offset:56904
    v_add_u32 v239, 1, v238
    v_min_u32 v239, s52, v239
    v_lshlrev_b32 v239, 4, v239
    ds_read_b64 v[242:243], v239 offset:56896
    ds_read_b64 v[210:211], v239 offset:56904
    v_add_u32 v239, 2, v238
    v_min_u32 v239, s52, v239
    v_lshlrev_b32 v239, 4, v239
    ds_read_b64 v[244:245], v239 offset:56896
    ds_read_b64 v[212:213], v239 offset:56904
    v_add_u32 v239, 3, v238
    v_min_u32 v239, s52, v239
    v_lshlrev_b32 v239, 4, v239
    ds_read_b64 v[246:247], v239 offset:56896
    ds_read_b64 v[214:215], v239 offset:56904
    s_waitcnt lgkmcnt(0)
    v_lshrrev_b32 v237, 5, v237
    v_lshlrev_b32 v237, 5, v237
    v_add_u32 v237, v237, v3
    buffer_load_dwordx2 v[204:205], v237, s[8:11], 0 offen
    v_lshlrev_b32 v248, 9, v241
    v_add_u32 v248, v248, v4
    buffer_load_dwordx2 v[140:141], v248, s[4:7], 0 offen offset:0
    buffer_load_dwordx2 v[142:143], v248, s[4:7], 0 offen offset:128
    buffer_load_dwordx2 v[144:145], v248, s[4:7], 0 offen offset:256
    buffer_load_dwordx2 v[146:147], v248, s[4:7], 0 offen offset:384
    v_lshlrev_b32 v248, 9, v243
    v_add_u32 v249, v248, v4
    buffer_load_dwordx2 v[148:149], v249, s[4:7], 0 offen offset:0
    buffer_load_dwordx2 v[150:151], v249, s[4:7], 0 offen offset:128
    buffer_load_dwordx2 v[152:153], v249, s[4:7], 0 offen offset:256
    buffer_load_dwordx2 v[154:155], v249, s[4:7], 0 offen offset:384
    v_lshlrev_b32 v248, 9, v245
    v_add_u32 v250, v248, v4
    buffer_load_dwordx2 v[156:157], v250, s[4:7], 0 offen offset:0
    buffer_load_dwordx2 v[158:159], v250, s[4:7], 0 offen offset:128
    buffer_load_dwordx2 v[160:161], v250, s[4:7], 0 offen offset:256
    buffer_load_dwordx2 v[162:163], v250, s[4:7], 0 offen offset:384
    v_lshlrev_b32 v248, 9, v247
    v_add_u32 v251, v248, v4
    buffer_load_dwordx2 v[164:165], v251, s[4:7], 0 offen offset:0
    buffer_load_dwordx2 v[166:167], v251, s[4:7], 0 offen offset:128
    buffer_load_dwordx2 v[168:169], v251, s[4:7], 0 offen offset:256
    buffer_load_dwordx2 v[170:171], v251, s[4:7], 0 offen offset:384
    s_waitcnt vmcnt(17)
    s_mov_b32 s56, 1
    s_branch M_COMP1
M_NONEXT1:
    s_waitcnt vmcnt(0)
    s_mov_b32 s56, 0
M_COMP1:
    v_cndmask_b32 v206, 0, v206, s[42:43]
    v_cndmask_b32 v207, 0, v207, s[42:43]
    v_lshlrev_b32 v224, 16, v216
    v_and_b32 v225, 0xffff0000, v216
    v_lshlrev_b32 v226, 16, v217
    v_lshlrev_b32 v227, 16, v218
    v_and_b32 v228, 0xffff0000, v218
    v_lshlrev_b32 v229, 16, v219
    v_lshlrev_b32 v230, 16, v220
    v_and_b32 v231, 0xffff0000, v220
    v_lshlrev_b32 v232, 16, v221
    v_lshlrev_b32 v233, 16, v222
    v_and_b32 v234, 0xffff0000, v222
    v_lshlrev_b32 v235, 16, v223
    v_mfma_f32_16x16x16_bf16 v[100:103], v[206:207], v[16:17], 0
    v_mfma_f32_16x16x16_bf16 v[104:107], v[206:207], v[18:19], 0
    v_mfma_f32_16x16x16_bf16 v[108:111], v[206:207], v[24:25], 0
    v_mfma_f32_16x16x16_bf16 v[112:115], v[206:207], v[26:27], 0
    v_mfma_f32_16x16x16_bf16 v[116:119], v[206:207], v[32:33], 0
    v_mfma_f32_16x16x16_bf16 v[120:123], v[206:207], v[34:35], 0
    v_mfma_f32_16x16x16_bf16 v[124:127], v[206:207], v[40:41], 0
    v_mfma_f32_16x16x16_bf16 v[128:131], v[206:207], v[42:43], 0
    v_mfma_f32_16x16x16_bf16 v[132:135], v[206:207], v[48:49], 0
    v_mfma_f32_16x16x16_bf16 v[136:139], v[206:207], v[50:51], 0
    s_nop 7
    v_lshlrev_b32 v250, 16, v172
    v_lshlrev_b32 v251, 16, v174
    v_lshlrev_b32 v252, 16, v176
    v_lshlrev_b32 v253, 16, v178
    v_fmac_f32 v56, v250, v100
    v_mul_f32 v254, v251, v224
    v_fmac_f32 v254, v252, v225
    v_fmac_f32 v254, v253, v226
    v_fmac_f32 v60, v254, v108
    v_mul_f32 v255, v250, v116
    v_fmac_f32 v64, v255, v224
    v_fmac_f32 v68, v255, v225
    v_fmac_f32 v72, v255, v226
    v_fmac_f32 v76, v251, v124
    v_fmac_f32 v80, v252, v124
    v_fmac_f32 v84, v253, v124
    v_mul_f32 v254, v253, v225
    v_fma_f32 v254, -v252, v226, v254
    v_fmac_f32 v88, v254, v132
    v_mul_f32 v254, v251, v226
    v_fma_f32 v254, -v253, v224, v254
    v_fmac_f32 v92, v254, v132
    v_mul_f32 v254, v252, v224
    v_fma_f32 v254, -v251, v225, v254
    v_fmac_f32 v96, v254, v132
    v_and_b32 v250, 0xffff0000, v172
    v_and_b32 v251, 0xffff0000, v174
    v_and_b32 v252, 0xffff0000, v176
    v_and_b32 v253, 0xffff0000, v178
    v_fmac_f32 v57, v250, v104
    v_mul_f32 v254, v251, v224
    v_fmac_f32 v254, v252, v225
    v_fmac_f32 v254, v253, v226
    v_fmac_f32 v61, v254, v112
    v_mul_f32 v255, v250, v120
    v_fmac_f32 v65, v255, v224
    v_fmac_f32 v69, v255, v225
    v_fmac_f32 v73, v255, v226
    v_fmac_f32 v77, v251, v128
    v_fmac_f32 v81, v252, v128
    v_fmac_f32 v85, v253, v128
    v_mul_f32 v254, v253, v225
    v_fma_f32 v254, -v252, v226, v254
    v_fmac_f32 v89, v254, v136
    v_mul_f32 v254, v251, v226
    v_fma_f32 v254, -v253, v224, v254
    v_fmac_f32 v93, v254, v136
    v_mul_f32 v254, v252, v224
    v_fma_f32 v254, -v251, v225, v254
    v_fmac_f32 v97, v254, v136
    v_lshlrev_b32 v250, 16, v180
    v_lshlrev_b32 v251, 16, v182
    v_lshlrev_b32 v252, 16, v184
    v_lshlrev_b32 v253, 16, v186
    v_fmac_f32 v56, v250, v101
    v_mul_f32 v254, v251, v227
    v_fmac_f32 v254, v252, v228
    v_fmac_f32 v254, v253, v229
    v_fmac_f32 v60, v254, v109
    v_mul_f32 v255, v250, v117
    v_fmac_f32 v64, v255, v227
    v_fmac_f32 v68, v255, v228
    v_fmac_f32 v72, v255, v229
    v_fmac_f32 v76, v251, v125
    v_fmac_f32 v80, v252, v125
    v_fmac_f32 v84, v253, v125
    v_mul_f32 v254, v253, v228
    v_fma_f32 v254, -v252, v229, v254
    v_fmac_f32 v88, v254, v133
    v_mul_f32 v254, v251, v229
    v_fma_f32 v254, -v253, v227, v254
    v_fmac_f32 v92, v254, v133
    v_mul_f32 v254, v252, v227
    v_fma_f32 v254, -v251, v228, v254
    v_fmac_f32 v96, v254, v133
    v_and_b32 v250, 0xffff0000, v180
    v_and_b32 v251, 0xffff0000, v182
    v_and_b32 v252, 0xffff0000, v184
    v_and_b32 v253, 0xffff0000, v186
    v_fmac_f32 v57, v250, v105
    v_mul_f32 v254, v251, v227
    v_fmac_f32 v254, v252, v228
    v_fmac_f32 v254, v253, v229
    v_fmac_f32 v61, v254, v113
    v_mul_f32 v255, v250, v121
    v_fmac_f32 v65, v255, v227
    v_fmac_f32 v69, v255, v228
    v_fmac_f32 v73, v255, v229
    v_fmac_f32 v77, v251, v129
    v_fmac_f32 v81, v252, v129
    v_fmac_f32 v85, v253, v129
    v_mul_f32 v254, v253, v228
    v_fma_f32 v254, -v252, v229, v254
    v_fmac_f32 v89, v254, v137
    v_mul_f32 v254, v251, v229
    v_fma_f32 v254, -v253, v227, v254
    v_fmac_f32 v93, v254, v137
    v_mul_f32 v254, v252, v227
    v_fma_f32 v254, -v251, v228, v254
    v_fmac_f32 v97, v254, v137
    v_lshlrev_b32 v250, 16, v188
    v_lshlrev_b32 v251, 16, v190
    v_lshlrev_b32 v252, 16, v192
    v_lshlrev_b32 v253, 16, v194
    v_fmac_f32 v56, v250, v102
    v_mul_f32 v254, v251, v230
    v_fmac_f32 v254, v252, v231
    v_fmac_f32 v254, v253, v232
    v_fmac_f32 v60, v254, v110
    v_mul_f32 v255, v250, v118
    v_fmac_f32 v64, v255, v230
    v_fmac_f32 v68, v255, v231
    v_fmac_f32 v72, v255, v232
    v_fmac_f32 v76, v251, v126
    v_fmac_f32 v80, v252, v126
    v_fmac_f32 v84, v253, v126
    v_mul_f32 v254, v253, v231
    v_fma_f32 v254, -v252, v232, v254
    v_fmac_f32 v88, v254, v134
    v_mul_f32 v254, v251, v232
    v_fma_f32 v254, -v253, v230, v254
    v_fmac_f32 v92, v254, v134
    v_mul_f32 v254, v252, v230
    v_fma_f32 v254, -v251, v231, v254
    v_fmac_f32 v96, v254, v134
    v_and_b32 v250, 0xffff0000, v188
    v_and_b32 v251, 0xffff0000, v190
    v_and_b32 v252, 0xffff0000, v192
    v_and_b32 v253, 0xffff0000, v194
    v_fmac_f32 v57, v250, v106
    v_mul_f32 v254, v251, v230
    v_fmac_f32 v254, v252, v231
    v_fmac_f32 v254, v253, v232
    v_fmac_f32 v61, v254, v114
    v_mul_f32 v255, v250, v122
    v_fmac_f32 v65, v255, v230
    v_fmac_f32 v69, v255, v231
    v_fmac_f32 v73, v255, v232
    v_fmac_f32 v77, v251, v130
    v_fmac_f32 v81, v252, v130
    v_fmac_f32 v85, v253, v130
    v_mul_f32 v254, v253, v231
    v_fma_f32 v254, -v252, v232, v254
    v_fmac_f32 v89, v254, v138
    v_mul_f32 v254, v251, v232
    v_fma_f32 v254, -v253, v230, v254
    v_fmac_f32 v93, v254, v138
    v_mul_f32 v254, v252, v230
    v_fma_f32 v254, -v251, v231, v254
    v_fmac_f32 v97, v254, v138
    v_lshlrev_b32 v250, 16, v196
    v_lshlrev_b32 v251, 16, v198
    v_lshlrev_b32 v252, 16, v200
    v_lshlrev_b32 v253, 16, v202
    v_fmac_f32 v56, v250, v103
    v_mul_f32 v254, v251, v233
    v_fmac_f32 v254, v252, v234
    v_fmac_f32 v254, v253, v235
    v_fmac_f32 v60, v254, v111
    v_mul_f32 v255, v250, v119
    v_fmac_f32 v64, v255, v233
    v_fmac_f32 v68, v255, v234
    v_fmac_f32 v72, v255, v235
    v_fmac_f32 v76, v251, v127
    v_fmac_f32 v80, v252, v127
    v_fmac_f32 v84, v253, v127
    v_mul_f32 v254, v253, v234
    v_fma_f32 v254, -v252, v235, v254
    v_fmac_f32 v88, v254, v135
    v_mul_f32 v254, v251, v235
    v_fma_f32 v254, -v253, v233, v254
    v_fmac_f32 v92, v254, v135
    v_mul_f32 v254, v252, v233
    v_fma_f32 v254, -v251, v234, v254
    v_fmac_f32 v96, v254, v135
    v_and_b32 v250, 0xffff0000, v196
    v_and_b32 v251, 0xffff0000, v198
    v_and_b32 v252, 0xffff0000, v200
    v_and_b32 v253, 0xffff0000, v202
    v_fmac_f32 v57, v250, v107
    v_mul_f32 v254, v251, v233
    v_fmac_f32 v254, v252, v234
    v_fmac_f32 v254, v253, v235
    v_fmac_f32 v61, v254, v115
    v_mul_f32 v255, v250, v123
    v_fmac_f32 v65, v255, v233
    v_fmac_f32 v69, v255, v234
    v_fmac_f32 v73, v255, v235
    v_fmac_f32 v77, v251, v131
    v_fmac_f32 v81, v252, v131
    v_fmac_f32 v85, v253, v131
    v_mul_f32 v254, v253, v234
    v_fma_f32 v254, -v252, v235, v254
    v_fmac_f32 v89, v254, v139
    v_mul_f32 v254, v251, v235
    v_fma_f32 v254, -v253, v233, v254
    v_fmac_f32 v93, v254, v139
    v_mul_f32 v254, v252, v233
    v_fma_f32 v254, -v251, v234, v254
    v_fmac_f32 v97, v254, v139
    v_mfma_f32_16x16x16_bf16 v[100:103], v[206:207], v[20:21], 0
    v_mfma_f32_16x16x16_bf16 v[104:107], v[206:207], v[22:23], 0
    v_mfma_f32_16x16x16_bf16 v[108:111], v[206:207], v[28:29], 0
    v_mfma_f32_16x16x16_bf16 v[112:115], v[206:207], v[30:31], 0
    v_mfma_f32_16x16x16_bf16 v[116:119], v[206:207], v[36:37], 0
    v_mfma_f32_16x16x16_bf16 v[120:123], v[206:207], v[38:39], 0
    v_mfma_f32_16x16x16_bf16 v[124:127], v[206:207], v[44:45], 0
    v_mfma_f32_16x16x16_bf16 v[128:131], v[206:207], v[46:47], 0
    v_mfma_f32_16x16x16_bf16 v[132:135], v[206:207], v[52:53], 0
    v_mfma_f32_16x16x16_bf16 v[136:139], v[206:207], v[54:55], 0
    s_nop 7
    v_lshlrev_b32 v250, 16, v173
    v_lshlrev_b32 v251, 16, v175
    v_lshlrev_b32 v252, 16, v177
    v_lshlrev_b32 v253, 16, v179
    v_fmac_f32 v58, v250, v100
    v_mul_f32 v254, v251, v224
    v_fmac_f32 v254, v252, v225
    v_fmac_f32 v254, v253, v226
    v_fmac_f32 v62, v254, v108
    v_mul_f32 v255, v250, v116
    v_fmac_f32 v66, v255, v224
    v_fmac_f32 v70, v255, v225
    v_fmac_f32 v74, v255, v226
    v_fmac_f32 v78, v251, v124
    v_fmac_f32 v82, v252, v124
    v_fmac_f32 v86, v253, v124
    v_mul_f32 v254, v253, v225
    v_fma_f32 v254, -v252, v226, v254
    v_fmac_f32 v90, v254, v132
    v_mul_f32 v254, v251, v226
    v_fma_f32 v254, -v253, v224, v254
    v_fmac_f32 v94, v254, v132
    v_mul_f32 v254, v252, v224
    v_fma_f32 v254, -v251, v225, v254
    v_fmac_f32 v98, v254, v132
    v_and_b32 v250, 0xffff0000, v173
    v_and_b32 v251, 0xffff0000, v175
    v_and_b32 v252, 0xffff0000, v177
    v_and_b32 v253, 0xffff0000, v179
    v_fmac_f32 v59, v250, v104
    v_mul_f32 v254, v251, v224
    v_fmac_f32 v254, v252, v225
    v_fmac_f32 v254, v253, v226
    v_fmac_f32 v63, v254, v112
    v_mul_f32 v255, v250, v120
    v_fmac_f32 v67, v255, v224
    v_fmac_f32 v71, v255, v225
    v_fmac_f32 v75, v255, v226
    v_fmac_f32 v79, v251, v128
    v_fmac_f32 v83, v252, v128
    v_fmac_f32 v87, v253, v128
    v_mul_f32 v254, v253, v225
    v_fma_f32 v254, -v252, v226, v254
    v_fmac_f32 v91, v254, v136
    v_mul_f32 v254, v251, v226
    v_fma_f32 v254, -v253, v224, v254
    v_fmac_f32 v95, v254, v136
    v_mul_f32 v254, v252, v224
    v_fma_f32 v254, -v251, v225, v254
    v_fmac_f32 v99, v254, v136
    v_lshlrev_b32 v250, 16, v181
    v_lshlrev_b32 v251, 16, v183
    v_lshlrev_b32 v252, 16, v185
    v_lshlrev_b32 v253, 16, v187
    v_fmac_f32 v58, v250, v101
    v_mul_f32 v254, v251, v227
    v_fmac_f32 v254, v252, v228
    v_fmac_f32 v254, v253, v229
    v_fmac_f32 v62, v254, v109
    v_mul_f32 v255, v250, v117
    v_fmac_f32 v66, v255, v227
    v_fmac_f32 v70, v255, v228
    v_fmac_f32 v74, v255, v229
    v_fmac_f32 v78, v251, v125
    v_fmac_f32 v82, v252, v125
    v_fmac_f32 v86, v253, v125
    v_mul_f32 v254, v253, v228
    v_fma_f32 v254, -v252, v229, v254
    v_fmac_f32 v90, v254, v133
    v_mul_f32 v254, v251, v229
    v_fma_f32 v254, -v253, v227, v254
    v_fmac_f32 v94, v254, v133
    v_mul_f32 v254, v252, v227
    v_fma_f32 v254, -v251, v228, v254
    v_fmac_f32 v98, v254, v133
    v_and_b32 v250, 0xffff0000, v181
    v_and_b32 v251, 0xffff0000, v183
    v_and_b32 v252, 0xffff0000, v185
    v_and_b32 v253, 0xffff0000, v187
    v_fmac_f32 v59, v250, v105
    v_mul_f32 v254, v251, v227
    v_fmac_f32 v254, v252, v228
    v_fmac_f32 v254, v253, v229
    v_fmac_f32 v63, v254, v113
    v_mul_f32 v255, v250, v121
    v_fmac_f32 v67, v255, v227
    v_fmac_f32 v71, v255, v228
    v_fmac_f32 v75, v255, v229
    v_fmac_f32 v79, v251, v129
    v_fmac_f32 v83, v252, v129
    v_fmac_f32 v87, v253, v129
    v_mul_f32 v254, v253, v228
    v_fma_f32 v254, -v252, v229, v254
    v_fmac_f32 v91, v254, v137
    v_mul_f32 v254, v251, v229
    v_fma_f32 v254, -v253, v227, v254
    v_fmac_f32 v95, v254, v137
    v_mul_f32 v254, v252, v227
    v_fma_f32 v254, -v251, v228, v254
    v_fmac_f32 v99, v254, v137
    v_lshlrev_b32 v250, 16, v189
    v_lshlrev_b32 v251, 16, v191
    v_lshlrev_b32 v252, 16, v193
    v_lshlrev_b32 v253, 16, v195
    v_fmac_f32 v58, v250, v102
    v_mul_f32 v254, v251, v230
    v_fmac_f32 v254, v252, v231
    v_fmac_f32 v254, v253, v232
    v_fmac_f32 v62, v254, v110
    v_mul_f32 v255, v250, v118
    v_fmac_f32 v66, v255, v230
    v_fmac_f32 v70, v255, v231
    v_fmac_f32 v74, v255, v232
    v_fmac_f32 v78, v251, v126
    v_fmac_f32 v82, v252, v126
    v_fmac_f32 v86, v253, v126
    v_mul_f32 v254, v253, v231
    v_fma_f32 v254, -v252, v232, v254
    v_fmac_f32 v90, v254, v134
    v_mul_f32 v254, v251, v232
    v_fma_f32 v254, -v253, v230, v254
    v_fmac_f32 v94, v254, v134
    v_mul_f32 v254, v252, v230
    v_fma_f32 v254, -v251, v231, v254
    v_fmac_f32 v98, v254, v134
    v_and_b32 v250, 0xffff0000, v189
    v_and_b32 v251, 0xffff0000, v191
    v_and_b32 v252, 0xffff0000, v193
    v_and_b32 v253, 0xffff0000, v195
    v_fmac_f32 v59, v250, v106
    v_mul_f32 v254, v251, v230
    v_fmac_f32 v254, v252, v231
    v_fmac_f32 v254, v253, v232
    v_fmac_f32 v63, v254, v114
    v_mul_f32 v255, v250, v122
    v_fmac_f32 v67, v255, v230
    v_fmac_f32 v71, v255, v231
    v_fmac_f32 v75, v255, v232
    v_fmac_f32 v79, v251, v130
    v_fmac_f32 v83, v252, v130
    v_fmac_f32 v87, v253, v130
    v_mul_f32 v254, v253, v231
    v_fma_f32 v254, -v252, v232, v254
    v_fmac_f32 v91, v254, v138
    v_mul_f32 v254, v251, v232
    v_fma_f32 v254, -v253, v230, v254
    v_fmac_f32 v95, v254, v138
    v_mul_f32 v254, v252, v230
    v_fma_f32 v254, -v251, v231, v254
    v_fmac_f32 v99, v254, v138
    v_lshlrev_b32 v250, 16, v197
    v_lshlrev_b32 v251, 16, v199
    v_lshlrev_b32 v252, 16, v201
    v_lshlrev_b32 v253, 16, v203
    v_fmac_f32 v58, v250, v103
    v_mul_f32 v254, v251, v233
    v_fmac_f32 v254, v252, v234
    v_fmac_f32 v254, v253, v235
    v_fmac_f32 v62, v254, v111
    v_mul_f32 v255, v250, v119
    v_fmac_f32 v66, v255, v233
    v_fmac_f32 v70, v255, v234
    v_fmac_f32 v74, v255, v235
    v_fmac_f32 v78, v251, v127
    v_fmac_f32 v82, v252, v127
    v_fmac_f32 v86, v253, v127
    v_mul_f32 v254, v253, v234
    v_fma_f32 v254, -v252, v235, v254
    v_fmac_f32 v90, v254, v135
    v_mul_f32 v254, v251, v235
    v_fma_f32 v254, -v253, v233, v254
    v_fmac_f32 v94, v254, v135
    v_mul_f32 v254, v252, v233
    v_fma_f32 v254, -v251, v234, v254
    v_fmac_f32 v98, v254, v135
    v_and_b32 v250, 0xffff0000, v197
    v_and_b32 v251, 0xffff0000, v199
    v_and_b32 v252, 0xffff0000, v201
    v_and_b32 v253, 0xffff0000, v203
    v_fmac_f32 v59, v250, v107
    v_mul_f32 v254, v251, v233
    v_fmac_f32 v254, v252, v234
    v_fmac_f32 v254, v253, v235
    v_fmac_f32 v63, v254, v115
    v_mul_f32 v255, v250, v123
    v_fmac_f32 v67, v255, v233
    v_fmac_f32 v71, v255, v234
    v_fmac_f32 v75, v255, v235
    v_fmac_f32 v79, v251, v131
    v_fmac_f32 v83, v252, v131
    v_fmac_f32 v87, v253, v131
    v_mul_f32 v254, v253, v234
    v_fma_f32 v254, -v252, v235, v254
    v_fmac_f32 v91, v254, v139
    v_mul_f32 v254, v251, v235
    v_fma_f32 v254, -v253, v233, v254
    v_fmac_f32 v95, v254, v139
    v_mul_f32 v254, v252, v233
    v_fma_f32 v254, -v251, v234, v254
    v_fmac_f32 v99, v254, v139
    s_add_u32 s47, s57, 16
    s_cmp_lt_u32 s47, s58
    s_cbranch_scc1 M_NOFLUSH1
    s_mov_b32 s53, s59
    v_mov_b32 v237, v56
    v_mov_b32 v238, v57
    v_mov_b32 v239, v58
    v_mov_b32 v240, v59
    s_nop 0
    v_permlane32_swap_b32 v56, v237
    v_permlane32_swap_b32 v57, v238
    v_permlane32_swap_b32 v58, v239
    v_permlane32_swap_b32 v59, v240
    v_add_f32 v56, v56, v237
    v_add_f32 v57, v57, v238
    v_add_f32 v58, v58, v239
    v_add_f32 v59, v59, v240
    v_mov_b32 v237, v56
    v_mov_b32 v238, v57
    v_mov_b32 v239, v58
    v_mov_b32 v240, v59
    s_nop 0
    v_permlane16_swap_b32 v56, v237
    v_permlane16_swap_b32 v57, v238
    v_permlane16_swap_b32 v58, v239
    v_permlane16_swap_b32 v59, v240
    v_add_f32 v56, v56, v237
    v_add_f32 v57, v57, v238
    v_add_f32 v58, v58, v239
    v_add_f32 v59, v59, v240
    v_mov_b32 v237, v60
    v_mov_b32 v238, v61
    v_mov_b32 v239, v62
    v_mov_b32 v240, v63
    s_nop 0
    v_permlane32_swap_b32 v60, v237
    v_permlane32_swap_b32 v61, v238
    v_permlane32_swap_b32 v62, v239
    v_permlane32_swap_b32 v63, v240
    v_add_f32 v60, v60, v237
    v_add_f32 v61, v61, v238
    v_add_f32 v62, v62, v239
    v_add_f32 v63, v63, v240
    v_mov_b32 v237, v60
    v_mov_b32 v238, v61
    v_mov_b32 v239, v62
    v_mov_b32 v240, v63
    s_nop 0
    v_permlane16_swap_b32 v60, v237
    v_permlane16_swap_b32 v61, v238
    v_permlane16_swap_b32 v62, v239
    v_permlane16_swap_b32 v63, v240
    v_add_f32 v60, v60, v237
    v_add_f32 v61, v61, v238
    v_add_f32 v62, v62, v239
    v_add_f32 v63, v63, v240
    v_mov_b32 v237, v64
    v_mov_b32 v238, v65
    v_mov_b32 v239, v66
    v_mov_b32 v240, v67
    s_nop 0
    v_permlane32_swap_b32 v64, v237
    v_permlane32_swap_b32 v65, v238
    v_permlane32_swap_b32 v66, v239
    v_permlane32_swap_b32 v67, v240
    v_add_f32 v64, v64, v237
    v_add_f32 v65, v65, v238
    v_add_f32 v66, v66, v239
    v_add_f32 v67, v67, v240
    v_mov_b32 v237, v64
    v_mov_b32 v238, v65
    v_mov_b32 v239, v66
    v_mov_b32 v240, v67
    s_nop 0
    v_permlane16_swap_b32 v64, v237
    v_permlane16_swap_b32 v65, v238
    v_permlane16_swap_b32 v66, v239
    v_permlane16_swap_b32 v67, v240
    v_add_f32 v64, v64, v237
    v_add_f32 v65, v65, v238
    v_add_f32 v66, v66, v239
    v_add_f32 v67, v67, v240
    v_mov_b32 v237, v68
    v_mov_b32 v238, v69
    v_mov_b32 v239, v70
    v_mov_b32 v240, v71
    s_nop 0
    v_permlane32_swap_b32 v68, v237
    v_permlane32_swap_b32 v69, v238
    v_permlane32_swap_b32 v70, v239
    v_permlane32_swap_b32 v71, v240
    v_add_f32 v68, v68, v237
    v_add_f32 v69, v69, v238
    v_add_f32 v70, v70, v239
    v_add_f32 v71, v71, v240
    v_mov_b32 v237, v68
    v_mov_b32 v238, v69
    v_mov_b32 v239, v70
    v_mov_b32 v240, v71
    s_nop 0
    v_permlane16_swap_b32 v68, v237
    v_permlane16_swap_b32 v69, v238
    v_permlane16_swap_b32 v70, v239
    v_permlane16_swap_b32 v71, v240
    v_add_f32 v68, v68, v237
    v_add_f32 v69, v69, v238
    v_add_f32 v70, v70, v239
    v_add_f32 v71, v71, v240
    v_mov_b32 v237, v72
    v_mov_b32 v238, v73
    v_mov_b32 v239, v74
    v_mov_b32 v240, v75
    s_nop 0
    v_permlane32_swap_b32 v72, v237
    v_permlane32_swap_b32 v73, v238
    v_permlane32_swap_b32 v74, v239
    v_permlane32_swap_b32 v75, v240
    v_add_f32 v72, v72, v237
    v_add_f32 v73, v73, v238
    v_add_f32 v74, v74, v239
    v_add_f32 v75, v75, v240
    v_mov_b32 v237, v72
    v_mov_b32 v238, v73
    v_mov_b32 v239, v74
    v_mov_b32 v240, v75
    s_nop 0
    v_permlane16_swap_b32 v72, v237
    v_permlane16_swap_b32 v73, v238
    v_permlane16_swap_b32 v74, v239
    v_permlane16_swap_b32 v75, v240
    v_add_f32 v72, v72, v237
    v_add_f32 v73, v73, v238
    v_add_f32 v74, v74, v239
    v_add_f32 v75, v75, v240
    v_mov_b32 v237, v76
    v_mov_b32 v238, v77
    v_mov_b32 v239, v78
    v_mov_b32 v240, v79
    s_nop 0
    v_permlane32_swap_b32 v76, v237
    v_permlane32_swap_b32 v77, v238
    v_permlane32_swap_b32 v78, v239
    v_permlane32_swap_b32 v79, v240
    v_add_f32 v76, v76, v237
    v_add_f32 v77, v77, v238
    v_add_f32 v78, v78, v239
    v_add_f32 v79, v79, v240
    v_mov_b32 v237, v76
    v_mov_b32 v238, v77
    v_mov_b32 v239, v78
    v_mov_b32 v240, v79
    s_nop 0
    v_permlane16_swap_b32 v76, v237
    v_permlane16_swap_b32 v77, v238
    v_permlane16_swap_b32 v78, v239
    v_permlane16_swap_b32 v79, v240
    v_add_f32 v76, v76, v237
    v_add_f32 v77, v77, v238
    v_add_f32 v78, v78, v239
    v_add_f32 v79, v79, v240
    v_mov_b32 v237, v80
    v_mov_b32 v238, v81
    v_mov_b32 v239, v82
    v_mov_b32 v240, v83
    s_nop 0
    v_permlane32_swap_b32 v80, v237
    v_permlane32_swap_b32 v81, v238
    v_permlane32_swap_b32 v82, v239
    v_permlane32_swap_b32 v83, v240
    v_add_f32 v80, v80, v237
    v_add_f32 v81, v81, v238
    v_add_f32 v82, v82, v239
    v_add_f32 v83, v83, v240
    v_mov_b32 v237, v80
    v_mov_b32 v238, v81
    v_mov_b32 v239, v82
    v_mov_b32 v240, v83
    s_nop 0
    v_permlane16_swap_b32 v80, v237
    v_permlane16_swap_b32 v81, v238
    v_permlane16_swap_b32 v82, v239
    v_permlane16_swap_b32 v83, v240
    v_add_f32 v80, v80, v237
    v_add_f32 v81, v81, v238
    v_add_f32 v82, v82, v239
    v_add_f32 v83, v83, v240
    v_mov_b32 v237, v84
    v_mov_b32 v238, v85
    v_mov_b32 v239, v86
    v_mov_b32 v240, v87
    s_nop 0
    v_permlane32_swap_b32 v84, v237
    v_permlane32_swap_b32 v85, v238
    v_permlane32_swap_b32 v86, v239
    v_permlane32_swap_b32 v87, v240
    v_add_f32 v84, v84, v237
    v_add_f32 v85, v85, v238
    v_add_f32 v86, v86, v239
    v_add_f32 v87, v87, v240
    v_mov_b32 v237, v84
    v_mov_b32 v238, v85
    v_mov_b32 v239, v86
    v_mov_b32 v240, v87
    s_nop 0
    v_permlane16_swap_b32 v84, v237
    v_permlane16_swap_b32 v85, v238
    v_permlane16_swap_b32 v86, v239
    v_permlane16_swap_b32 v87, v240
    v_add_f32 v84, v84, v237
    v_add_f32 v85, v85, v238
    v_add_f32 v86, v86, v239
    v_add_f32 v87, v87, v240
    v_mov_b32 v237, v88
    v_mov_b32 v238, v89
    v_mov_b32 v239, v90
    v_mov_b32 v240, v91
    s_nop 0
    v_permlane32_swap_b32 v88, v237
    v_permlane32_swap_b32 v89, v238
    v_permlane32_swap_b32 v90, v239
    v_permlane32_swap_b32 v91, v240
    v_add_f32 v88, v88, v237
    v_add_f32 v89, v89, v238
    v_add_f32 v90, v90, v239
    v_add_f32 v91, v91, v240
    v_mov_b32 v237, v88
    v_mov_b32 v238, v89
    v_mov_b32 v239, v90
    v_mov_b32 v240, v91
    s_nop 0
    v_permlane16_swap_b32 v88, v237
    v_permlane16_swap_b32 v89, v238
    v_permlane16_swap_b32 v90, v239
    v_permlane16_swap_b32 v91, v240
    v_add_f32 v88, v88, v237
    v_add_f32 v89, v89, v238
    v_add_f32 v90, v90, v239
    v_add_f32 v91, v91, v240
    v_mov_b32 v237, v92
    v_mov_b32 v238, v93
    v_mov_b32 v239, v94
    v_mov_b32 v240, v95
    s_nop 0
    v_permlane32_swap_b32 v92, v237
    v_permlane32_swap_b32 v93, v238
    v_permlane32_swap_b32 v94, v239
    v_permlane32_swap_b32 v95, v240
    v_add_f32 v92, v92, v237
    v_add_f32 v93, v93, v238
    v_add_f32 v94, v94, v239
    v_add_f32 v95, v95, v240
    v_mov_b32 v237, v92
    v_mov_b32 v238, v93
    v_mov_b32 v239, v94
    v_mov_b32 v240, v95
    s_nop 0
    v_permlane16_swap_b32 v92, v237
    v_permlane16_swap_b32 v93, v238
    v_permlane16_swap_b32 v94, v239
    v_permlane16_swap_b32 v95, v240
    v_add_f32 v92, v92, v237
    v_add_f32 v93, v93, v238
    v_add_f32 v94, v94, v239
    v_add_f32 v95, v95, v240
    v_mov_b32 v237, v96
    v_mov_b32 v238, v97
    v_mov_b32 v239, v98
    v_mov_b32 v240, v99
    s_nop 0
    v_permlane32_swap_b32 v96, v237
    v_permlane32_swap_b32 v97, v238
    v_permlane32_swap_b32 v98, v239
    v_permlane32_swap_b32 v99, v240
    v_add_f32 v96, v96, v237
    v_add_f32 v97, v97, v238
    v_add_f32 v98, v98, v239
    v_add_f32 v99, v99, v240
    v_mov_b32 v237, v96
    v_mov_b32 v238, v97
    v_mov_b32 v239, v98
    v_mov_b32 v240, v99
    s_nop 0
    v_permlane16_swap_b32 v96, v237
    v_permlane16_swap_b32 v97, v238
    v_permlane16_swap_b32 v98, v239
    v_permlane16_swap_b32 v99, v240
    v_add_f32 v96, v96, v237
    v_add_f32 v97, v97, v238
    v_add_f32 v98, v98, v239
    v_add_f32 v99, v99, v240
    s_mul_i32 s54, s53, 2832
    v_add_u32 v236, s54, v5
    s_mov_b64 exec, 0xffff
    ds_read_b128 v[100:103], v236 offset:256
    ds_read_b128 v[104:107], v236 offset:512
    ds_read_b128 v[108:111], v236 offset:768
    ds_read_b128 v[112:115], v236 offset:1536
    ds_read_b128 v[116:119], v236 offset:2304
    ds_read_b128 v[120:123], v236 offset:1024
    ds_read_b128 v[124:127], v236 offset:1792
    ds_read_b128 v[128:131], v236 offset:2560
    ds_read_b128 v[132:135], v236 offset:1280
    ds_read_b128 v[136:139], v236 offset:2048
    s_waitcnt lgkmcnt(0)
    v_add_f32 v56, v56, v100
    v_add_f32 v57, v57, v101
    v_add_f32 v58, v58, v102
    v_add_f32 v59, v59, v103
    v_add_f32 v60, v60, v104
    v_add_f32 v61, v61, v105
    v_add_f32 v62, v62, v106
    v_add_f32 v63, v63, v107
    v_add_f32 v64, v64, v108
    v_add_f32 v65, v65, v109
    v_add_f32 v66, v66, v110
    v_add_f32 v67, v67, v111
    v_add_f32 v68, v68, v112
    v_add_f32 v69, v69, v113
    v_add_f32 v70, v70, v114
    v_add_f32 v71, v71, v115
    v_add_f32 v72, v72, v116
    v_add_f32 v73, v73, v117
    v_add_f32 v74, v74, v118
    v_add_f32 v75, v75, v119
    v_add_f32 v76, v76, v120
    v_add_f32 v77, v77, v121
    v_add_f32 v78, v78, v122
    v_add_f32 v79, v79, v123
    v_add_f32 v80, v80, v124
    v_add_f32 v81, v81, v125
    v_add_f32 v82, v82, v126
    v_add_f32 v83, v83, v127
    v_add_f32 v84, v84, v128
    v_add_f32 v85, v85, v129
    v_add_f32 v86, v86, v130
    v_add_f32 v87, v87, v131
    v_add_f32 v88, v88, v132
    v_add_f32 v89, v89, v133
    v_add_f32 v90, v90, v134
    v_add_f32 v91, v91, v135
    v_add_f32 v92, v92, v136
    v_add_f32 v93, v93, v137
    v_add_f32 v94, v94, v138
    v_add_f32 v95, v95, v139
    ds_read_b128 v[100:103], v236 offset:2816
    s_waitcnt lgkmcnt(0)
    v_add_f32 v96, v96, v100
    v_add_f32 v97, v97, v101
    v_add_f32 v98, v98, v102
    v_add_f32 v99, v99, v103
    ds_write_b128 v236, v[56:59] offset:256
    ds_write_b128 v236, v[60:63] offset:512
    ds_write_b128 v236, v[64:67] offset:768
    ds_write_b128 v236, v[68:71] offset:1536
    ds_write_b128 v236, v[72:75] offset:2304
    ds_write_b128 v236, v[76:79] offset:1024
    ds_write_b128 v236, v[80:83] offset:1792
    ds_write_b128 v236, v[84:87] offset:2560
    ds_write_b128 v236, v[88:91] offset:1280
    ds_write_b128 v236, v[92:95] offset:2048
    ds_write_b128 v236, v[96:99] offset:2816
    s_mov_b64 exec, -1
    s_waitcnt lgkmcnt(0)
    v_mov_b32 v56, 0
    v_mov_b32 v57, 0
    v_mov_b32 v58, 0
    v_mov_b32 v59, 0
    v_mov_b32 v60, 0
    v_mov_b32 v61, 0
    v_mov_b32 v62, 0
    v_mov_b32 v63, 0
    v_mov_b32 v64, 0
    v_mov_b32 v65, 0
    v_mov_b32 v66, 0
    v_mov_b32 v67, 0
    v_mov_b32 v68, 0
    v_mov_b32 v69, 0
    v_mov_b32 v70, 0
    v_mov_b32 v71, 0
    v_mov_b32 v72, 0
    v_mov_b32 v73, 0
    v_mov_b32 v74, 0
    v_mov_b32 v75, 0
    v_mov_b32 v76, 0
    v_mov_b32 v77, 0
    v_mov_b32 v78, 0
    v_mov_b32 v79, 0
    v_mov_b32 v80, 0
    v_mov_b32 v81, 0
    v_mov_b32 v82, 0
    v_mov_b32 v83, 0
    v_mov_b32 v84, 0
    v_mov_b32 v85, 0
    v_mov_b32 v86, 0
    v_mov_b32 v87, 0
    v_mov_b32 v88, 0
    v_mov_b32 v89, 0
    v_mov_b32 v90, 0
    v_mov_b32 v91, 0
    v_mov_b32 v92, 0
    v_mov_b32 v93, 0
    v_mov_b32 v94, 0
    v_mov_b32 v95, 0
    v_mov_b32 v96, 0
    v_mov_b32 v97, 0
    v_mov_b32 v98, 0
    v_mov_b32 v99, 0
M_NOFLUSH1:
    s_cmp_eq_u32 s56, 0
    s_cbranch_scc1 M_WAVEDONE
    s_mov_b32 s57, s50
    s_mov_b32 s58, s51
    s_mov_b32 s59, s48
    s_branch M_LOOP0
M_WAVEDONE:
    s_waitcnt vmcnt(0) lgkmcnt(0)
    s_barrier
    s_add_u32 s28, s28, s45
    s_cmp_lt_u32 s28, s29
    s_cbranch_scc1 M_PASS
    v_and_b32 v6, 63, v0
    v_lshlrev_b32 v7, 4, v6
    s_lshl_b32 s47, s44, 2
    s_add_u32 s47, s47, 0
    s_lshl_b32 s47, s47, 10
    s_add_u32 s47, s47, 147456
    buffer_load_dwordx4 v[16:19], v7, s[12:15], s47 offen
    s_lshl_b32 s47, s44, 2
    s_add_u32 s47, s47, 1
    s_lshl_b32 s47, s47, 10
    s_add_u32 s47, s47, 147456
    buffer_load_dwordx4 v[20:23], v7, s[12:15], s47 offen
    s_lshl_b32 s47, s44, 2
    s_add_u32 s47, s47, 2
    s_lshl_b32 s47, s47, 10
    s_add_u32 s47, s47, 147456
    buffer_load_dwordx4 v[24:27], v7, s[12:15], s47 offen
    s_lshl_b32 s47, s44, 2
    s_add_u32 s47, s47, 3
    s_lshl_b32 s47, s47, 10
    s_add_u32 s47, s47, 147456
    buffer_load_dwordx4 v[28:31], v7, s[12:15], s47 offen
    s_lshl_b32 s47, s44, 10
    s_add_u32 s47, s47, 163840
    buffer_load_dwordx4 v[32:35], v7, s[12:15], s47 offen
    s_lshl_b32 s47, s44, 10
    s_add_u32 s47, s47, 167936
    buffer_load_dwordx4 v[36:39], v7, s[12:15], s47 offen
    s_lshl_b32 s47, s44, 10
    s_add_u32 s47, s47, 172032
    buffer_load_dwordx4 v[40:43], v7, s[12:15], s47 offen
    s_lshl_b32 s47, s44, 10
    s_add_u32 s47, s47, 176128
    buffer_load_dwordx4 v[44:47], v7, s[12:15], s47 offen
    s_lshl_b32 s47, s44, 10
    s_add_u32 s47, s47, 180224
    buffer_load_dwordx4 v[48:51], v7, s[12:15], s47 offen
    s_lshl_b32 s47, s44, 10
    s_add_u32 s47, s47, 184320
    buffer_load_dwordx4 v[52:55], v7, s[12:15], s47 offen
    s_waitcnt vmcnt(0)
    s_mul_i32 s46, s2, 20
    v_add_u32 v7, 0, v1
    v_min_u32 v8, 19, v7
    v_mul_u32_u24 v8, 2832, v8
    v_lshl_add_u32 v8, v2, 3, v8
    v_mov_b32 v56, 0
    v_mov_b32 v57, 0
    v_mov_b32 v58, 0
    v_mov_b32 v59, 0
    v_mov_b32 v60, 0
    v_mov_b32 v61, 0
    v_mov_b32 v62, 0
    v_mov_b32 v63, 0
    v_mov_b32 v64, 0
    v_mov_b32 v65, 0
    v_mov_b32 v66, 0
    v_mov_b32 v67, 0
    v_mov_b32 v68, 0
    v_mov_b32 v69, 0
    v_mov_b32 v70, 0
    v_mov_b32 v71, 0
    ds_read_b128 v[100:103], v8 offset:256
    ds_read_b128 v[104:107], v8 offset:272
    s_waitcnt lgkmcnt(0)
    v_cvt_pk_bf16_f32 v108, v100, v101
    v_cvt_pk_bf16_f32 v109, v102, v103
    v_cvt_pk_bf16_f32 v110, v104, v105
    v_cvt_pk_bf16_f32 v111, v106, v107
    s_nop 1
    v_mfma_f32_16x16x32_bf16 v[56:59], v[16:19], v[108:111], v[56:59]
    ds_read_b128 v[100:103], v8 offset:384
    ds_read_b128 v[104:107], v8 offset:400
    s_waitcnt lgkmcnt(0)
    v_cvt_pk_bf16_f32 v108, v100, v101
    v_cvt_pk_bf16_f32 v109, v102, v103
    v_cvt_pk_bf16_f32 v110, v104, v105
    v_cvt_pk_bf16_f32 v111, v106, v107
    s_nop 1
    v_mfma_f32_16x16x32_bf16 v[56:59], v[20:23], v[108:111], v[56:59]
    ds_read_b128 v[100:103], v8 offset:512
    ds_read_b128 v[104:107], v8 offset:528
    s_waitcnt lgkmcnt(0)
    v_cvt_pk_bf16_f32 v108, v100, v101
    v_cvt_pk_bf16_f32 v109, v102, v103
    v_cvt_pk_bf16_f32 v110, v104, v105
    v_cvt_pk_bf16_f32 v111, v106, v107
    s_nop 1
    v_mfma_f32_16x16x32_bf16 v[56:59], v[24:27], v[108:111], v[56:59]
    ds_read_b128 v[100:103], v8 offset:640
    ds_read_b128 v[104:107], v8 offset:656
    s_waitcnt lgkmcnt(0)
    v_cvt_pk_bf16_f32 v108, v100, v101
    v_cvt_pk_bf16_f32 v109, v102, v103
    v_cvt_pk_bf16_f32 v110, v104, v105
    v_cvt_pk_bf16_f32 v111, v106, v107
    s_nop 1
    v_mfma_f32_16x16x32_bf16 v[56:59], v[28:31], v[108:111], v[56:59]
    ds_read_b128 v[100:103], v8 offset:768
    ds_read_b128 v[104:107], v8 offset:784
    s_waitcnt lgkmcnt(0)
    v_cvt_pk_bf16_f32 v108, v100, v101
    v_cvt_pk_bf16_f32 v109, v102, v103
    v_cvt_pk_bf16_f32 v110, v104, v105
    v_cvt_pk_bf16_f32 v111, v106, v107
    s_nop 1
    v_mfma_f32_16x16x32_bf16 v[60:63], v[32:35], v[108:111], v[60:63]
    ds_read_b128 v[100:103], v8 offset:896
    ds_read_b128 v[104:107], v8 offset:912
    s_waitcnt lgkmcnt(0)
    v_cvt_pk_bf16_f32 v108, v100, v101
    v_cvt_pk_bf16_f32 v109, v102, v103
    v_cvt_pk_bf16_f32 v110, v104, v105
    v_cvt_pk_bf16_f32 v111, v106, v107
    s_nop 1
    v_mfma_f32_16x16x32_bf16 v[60:63], v[36:39], v[108:111], v[60:63]
    ds_read_b128 v[100:103], v8 offset:1024
    ds_read_b128 v[104:107], v8 offset:1040
    s_waitcnt lgkmcnt(0)
    v_cvt_pk_bf16_f32 v108, v100, v101
    v_cvt_pk_bf16_f32 v109, v102, v103
    v_cvt_pk_bf16_f32 v110, v104, v105
    v_cvt_pk_bf16_f32 v111, v106, v107
    s_nop 1
    v_mfma_f32_16x16x32_bf16 v[60:63], v[40:43], v[108:111], v[60:63]
    ds_read_b128 v[100:103], v8 offset:1152
    ds_read_b128 v[104:107], v8 offset:1168
    s_waitcnt lgkmcnt(0)
    v_cvt_pk_bf16_f32 v108, v100, v101
    v_cvt_pk_bf16_f32 v109, v102, v103
    v_cvt_pk_bf16_f32 v110, v104, v105
    v_cvt_pk_bf16_f32 v111, v106, v107
    s_nop 1
    v_mfma_f32_16x16x32_bf16 v[60:63], v[44:47], v[108:111], v[60:63]
    ds_read_b128 v[100:103], v8 offset:1280
    ds_read_b128 v[104:107], v8 offset:1296
    s_waitcnt lgkmcnt(0)
    v_cvt_pk_bf16_f32 v108, v100, v101
    v_cvt_pk_bf16_f32 v109, v102, v103
    v_cvt_pk_bf16_f32 v110, v104, v105
    v_cvt_pk_bf16_f32 v111, v106, v107
    s_nop 1
    v_mfma_f32_16x16x32_bf16 v[60:63], v[48:51], v[108:111], v[60:63]
    ds_read_b128 v[100:103], v8 offset:1408
    ds_read_b128 v[104:107], v8 offset:1424
    s_waitcnt lgkmcnt(0)
    v_cvt_pk_bf16_f32 v108, v100, v101
    v_cvt_pk_bf16_f32 v109, v102, v103
    v_cvt_pk_bf16_f32 v110, v104, v105
    v_cvt_pk_bf16_f32 v111, v106, v107
    s_nop 1
    v_mfma_f32_16x16x32_bf16 v[60:63], v[52:55], v[108:111], v[60:63]
    ds_read_b128 v[100:103], v8 offset:1536
    ds_read_b128 v[104:107], v8 offset:1552
    s_waitcnt lgkmcnt(0)
    v_cvt_pk_bf16_f32 v108, v100, v101
    v_cvt_pk_bf16_f32 v109, v102, v103
    v_cvt_pk_bf16_f32 v110, v104, v105
    v_cvt_pk_bf16_f32 v111, v106, v107
    s_nop 1
    v_mfma_f32_16x16x32_bf16 v[64:67], v[32:35], v[108:111], v[64:67]
    ds_read_b128 v[100:103], v8 offset:1664
    ds_read_b128 v[104:107], v8 offset:1680
    s_waitcnt lgkmcnt(0)
    v_cvt_pk_bf16_f32 v108, v100, v101
    v_cvt_pk_bf16_f32 v109, v102, v103
    v_cvt_pk_bf16_f32 v110, v104, v105
    v_cvt_pk_bf16_f32 v111, v106, v107
    s_nop 1
    v_mfma_f32_16x16x32_bf16 v[64:67], v[36:39], v[108:111], v[64:67]
    ds_read_b128 v[100:103], v8 offset:1792
    ds_read_b128 v[104:107], v8 offset:1808
    s_waitcnt lgkmcnt(0)
    v_cvt_pk_bf16_f32 v108, v100, v101
    v_cvt_pk_bf16_f32 v109, v102, v103
    v_cvt_pk_bf16_f32 v110, v104, v105
    v_cvt_pk_bf16_f32 v111, v106, v107
    s_nop 1
    v_mfma_f32_16x16x32_bf16 v[64:67], v[40:43], v[108:111], v[64:67]
    ds_read_b128 v[100:103], v8 offset:1920
    ds_read_b128 v[104:107], v8 offset:1936
    s_waitcnt lgkmcnt(0)
    v_cvt_pk_bf16_f32 v108, v100, v101
    v_cvt_pk_bf16_f32 v109, v102, v103
    v_cvt_pk_bf16_f32 v110, v104, v105
    v_cvt_pk_bf16_f32 v111, v106, v107
    s_nop 1
    v_mfma_f32_16x16x32_bf16 v[64:67], v[44:47], v[108:111], v[64:67]
    ds_read_b128 v[100:103], v8 offset:2048
    ds_read_b128 v[104:107], v8 offset:2064
    s_waitcnt lgkmcnt(0)
    v_cvt_pk_bf16_f32 v108, v100, v101
    v_cvt_pk_bf16_f32 v109, v102, v103
    v_cvt_pk_bf16_f32 v110, v104, v105
    v_cvt_pk_bf16_f32 v111, v106, v107
    s_nop 1
    v_mfma_f32_16x16x32_bf16 v[64:67], v[48:51], v[108:111], v[64:67]
    ds_read_b128 v[100:103], v8 offset:2176
    ds_read_b128 v[104:107], v8 offset:2192
    s_waitcnt lgkmcnt(0)
    v_cvt_pk_bf16_f32 v108, v100, v101
    v_cvt_pk_bf16_f32 v109, v102, v103
    v_cvt_pk_bf16_f32 v110, v104, v105
    v_cvt_pk_bf16_f32 v111, v106, v107
    s_nop 1
    v_mfma_f32_16x16x32_bf16 v[64:67], v[52:55], v[108:111], v[64:67]
    ds_read_b128 v[100:103], v8 offset:2304
    ds_read_b128 v[104:107], v8 offset:2320
    s_waitcnt lgkmcnt(0)
    v_cvt_pk_bf16_f32 v108, v100, v101
    v_cvt_pk_bf16_f32 v109, v102, v103
    v_cvt_pk_bf16_f32 v110, v104, v105
    v_cvt_pk_bf16_f32 v111, v106, v107
    s_nop 1
    v_mfma_f32_16x16x32_bf16 v[68:71], v[32:35], v[108:111], v[68:71]
    ds_read_b128 v[100:103], v8 offset:2432
    ds_read_b128 v[104:107], v8 offset:2448
    s_waitcnt lgkmcnt(0)
    v_cvt_pk_bf16_f32 v108, v100, v101
    v_cvt_pk_bf16_f32 v109, v102, v103
    v_cvt_pk_bf16_f32 v110, v104, v105
    v_cvt_pk_bf16_f32 v111, v106, v107
    s_nop 1
    v_mfma_f32_16x16x32_bf16 v[68:71], v[36:39], v[108:111], v[68:71]
    ds_read_b128 v[100:103], v8 offset:2560
    ds_read_b128 v[104:107], v8 offset:2576
    s_waitcnt lgkmcnt(0)
    v_cvt_pk_bf16_f32 v108, v100, v101
    v_cvt_pk_bf16_f32 v109, v102, v103
    v_cvt_pk_bf16_f32 v110, v104, v105
    v_cvt_pk_bf16_f32 v111, v106, v107
    s_nop 1
    v_mfma_f32_16x16x32_bf16 v[68:71], v[40:43], v[108:111], v[68:71]
    ds_read_b128 v[100:103], v8 offset:2688
    ds_read_b128 v[104:107], v8 offset:2704
    s_waitcnt lgkmcnt(0)
    v_cvt_pk_bf16_f32 v108, v100, v101
    v_cvt_pk_bf16_f32 v109, v102, v103
    v_cvt_pk_bf16_f32 v110, v104, v105
    v_cvt_pk_bf16_f32 v111, v106, v107
    s_nop 1
    v_mfma_f32_16x16x32_bf16 v[68:71], v[44:47], v[108:111], v[68:71]
    ds_read_b128 v[100:103], v8 offset:2816
    ds_read_b128 v[104:107], v8 offset:2832
    s_waitcnt lgkmcnt(0)
    v_cvt_pk_bf16_f32 v108, v100, v101
    v_cvt_pk_bf16_f32 v109, v102, v103
    v_cvt_pk_bf16_f32 v110, v104, v105
    v_cvt_pk_bf16_f32 v111, v106, v107
    s_nop 1
    v_mfma_f32_16x16x32_bf16 v[68:71], v[48:51], v[108:111], v[68:71]
    ds_read_b128 v[100:103], v8 offset:2944
    ds_read_b128 v[104:107], v8 offset:2960
    s_waitcnt lgkmcnt(0)
    v_cvt_pk_bf16_f32 v108, v100, v101
    v_cvt_pk_bf16_f32 v109, v102, v103
    v_cvt_pk_bf16_f32 v110, v104, v105
    v_cvt_pk_bf16_f32 v111, v106, v107
    s_nop 1
    v_mfma_f32_16x16x32_bf16 v[68:71], v[52:55], v[108:111], v[68:71]
    s_nop 7
    s_nop 3
    v_cmp_gt_u32 vcc, 20, v7
    s_and_saveexec_b64 s[30:31], vcc
    s_mov_b32 s47, 0xbfb8aa3b
    v_mul_f32 v112, s47, v56
    v_exp_f32 v112, v112
    s_nop 0
    v_add_f32 v112, 1.0, v112
    v_rcp_f32 v112, v112
    s_nop 0
    v_mul_f32 v113, s47, v57
    v_exp_f32 v113, v113
    s_nop 0
    v_add_f32 v113, 1.0, v113
    v_rcp_f32 v113, v113
    s_nop 0
    v_mul_f32 v114, s47, v58
    v_exp_f32 v114, v114
    s_nop 0
    v_add_f32 v114, 1.0, v114
    v_rcp_f32 v114, v114
    s_nop 0
    v_mul_f32 v115, s47, v59
    v_exp_f32 v115, v115
    s_nop 0
    v_add_f32 v115, 1.0, v115
    v_rcp_f32 v115, v115
    s_nop 0
    v_add_u32 v9, s46, v7
    v_lshlrev_b32 v9, 9, v9
    s_lshl_b32 s47, s44, 5
    v_add_u32 v9, s47, v9
    v_lshl_add_u32 v9, v2, 1, v9
    v_cvt_pk_bf16_f32 v116, v56, v57
    v_cvt_pk_bf16_f32 v117, v58, v59
    buffer_store_dwordx2 v[116:117], v9, s[16:19], 0 offen
    v_mul_f32 v60, v60, v112
    v_mul_f32 v61, v61, v113
    v_mul_f32 v62, v62, v114
    v_mul_f32 v63, v63, v115
    v_cvt_pk_bf16_f32 v118, v60, v61
    v_cvt_pk_bf16_f32 v119, v62, v63
    buffer_store_dwordx2 v[118:119], v9, s[16:19], 0 offen offset:128
    v_mul_f32 v64, v64, v112
    v_mul_f32 v65, v65, v113
    v_mul_f32 v66, v66, v114
    v_mul_f32 v67, v67, v115
    v_cvt_pk_bf16_f32 v120, v64, v65
    v_cvt_pk_bf16_f32 v121, v66, v67
    buffer_store_dwordx2 v[120:121], v9, s[16:19], 0 offen offset:256
    v_mul_f32 v68, v68, v112
    v_mul_f32 v69, v69, v113
    v_mul_f32 v70, v70, v114
    v_mul_f32 v71, v71, v115
    v_cvt_pk_bf16_f32 v122, v68, v69
    v_cvt_pk_bf16_f32 v123, v70, v71
    buffer_store_dwordx2 v[122:123], v9, s[16:19], 0 offen offset:384
    s_mov_b64 exec, s[30:31]
    v_add_u32 v7, 16, v1
    v_min_u32 v8, 19, v7
    v_mul_u32_u24 v8, 2832, v8
    v_lshl_add_u32 v8, v2, 3, v8
    v_mov_b32 v56, 0
    v_mov_b32 v57, 0
    v_mov_b32 v58, 0
    v_mov_b32 v59, 0
    v_mov_b32 v60, 0
    v_mov_b32 v61, 0
    v_mov_b32 v62, 0
    v_mov_b32 v63, 0
    v_mov_b32 v64, 0
    v_mov_b32 v65, 0
    v_mov_b32 v66, 0
    v_mov_b32 v67, 0
    v_mov_b32 v68, 0
    v_mov_b32 v69, 0
    v_mov_b32 v70, 0
    v_mov_b32 v71, 0
    ds_read_b128 v[100:103], v8 offset:256
    ds_read_b128 v[104:107], v8 offset:272
    s_waitcnt lgkmcnt(0)
    v_cvt_pk_bf16_f32 v108, v100, v101
    v_cvt_pk_bf16_f32 v109, v102, v103
    v_cvt_pk_bf16_f32 v110, v104, v105
    v_cvt_pk_bf16_f32 v111, v106, v107
    s_nop 1
    v_mfma_f32_16x16x32_bf16 v[56:59], v[16:19], v[108:111], v[56:59]
    ds_read_b128 v[100:103], v8 offset:384
    ds_read_b128 v[104:107], v8 offset:400
    s_waitcnt lgkmcnt(0)
    v_cvt_pk_bf16_f32 v108, v100, v101
    v_cvt_pk_bf16_f32 v109, v102, v103
    v_cvt_pk_bf16_f32 v110, v104, v105
    v_cvt_pk_bf16_f32 v111, v106, v107
    s_nop 1
    v_mfma_f32_16x16x32_bf16 v[56:59], v[20:23], v[108:111], v[56:59]
    ds_read_b128 v[100:103], v8 offset:512
    ds_read_b128 v[104:107], v8 offset:528
    s_waitcnt lgkmcnt(0)
    v_cvt_pk_bf16_f32 v108, v100, v101
    v_cvt_pk_bf16_f32 v109, v102, v103
    v_cvt_pk_bf16_f32 v110, v104, v105
    v_cvt_pk_bf16_f32 v111, v106, v107
    s_nop 1
    v_mfma_f32_16x16x32_bf16 v[56:59], v[24:27], v[108:111], v[56:59]
    ds_read_b128 v[100:103], v8 offset:640
    ds_read_b128 v[104:107], v8 offset:656
    s_waitcnt lgkmcnt(0)
    v_cvt_pk_bf16_f32 v108, v100, v101
    v_cvt_pk_bf16_f32 v109, v102, v103
    v_cvt_pk_bf16_f32 v110, v104, v105
    v_cvt_pk_bf16_f32 v111, v106, v107
    s_nop 1
    v_mfma_f32_16x16x32_bf16 v[56:59], v[28:31], v[108:111], v[56:59]
    ds_read_b128 v[100:103], v8 offset:768
    ds_read_b128 v[104:107], v8 offset:784
    s_waitcnt lgkmcnt(0)
    v_cvt_pk_bf16_f32 v108, v100, v101
    v_cvt_pk_bf16_f32 v109, v102, v103
    v_cvt_pk_bf16_f32 v110, v104, v105
    v_cvt_pk_bf16_f32 v111, v106, v107
    s_nop 1
    v_mfma_f32_16x16x32_bf16 v[60:63], v[32:35], v[108:111], v[60:63]
    ds_read_b128 v[100:103], v8 offset:896
    ds_read_b128 v[104:107], v8 offset:912
    s_waitcnt lgkmcnt(0)
    v_cvt_pk_bf16_f32 v108, v100, v101
    v_cvt_pk_bf16_f32 v109, v102, v103
    v_cvt_pk_bf16_f32 v110, v104, v105
    v_cvt_pk_bf16_f32 v111, v106, v107
    s_nop 1
    v_mfma_f32_16x16x32_bf16 v[60:63], v[36:39], v[108:111], v[60:63]
    ds_read_b128 v[100:103], v8 offset:1024
    ds_read_b128 v[104:107], v8 offset:1040
    s_waitcnt lgkmcnt(0)
    v_cvt_pk_bf16_f32 v108, v100, v101
    v_cvt_pk_bf16_f32 v109, v102, v103
    v_cvt_pk_bf16_f32 v110, v104, v105
    v_cvt_pk_bf16_f32 v111, v106, v107
    s_nop 1
    v_mfma_f32_16x16x32_bf16 v[60:63], v[40:43], v[108:111], v[60:63]
    ds_read_b128 v[100:103], v8 offset:1152
    ds_read_b128 v[104:107], v8 offset:1168
    s_waitcnt lgkmcnt(0)
    v_cvt_pk_bf16_f32 v108, v100, v101
    v_cvt_pk_bf16_f32 v109, v102, v103
    v_cvt_pk_bf16_f32 v110, v104, v105
    v_cvt_pk_bf16_f32 v111, v106, v107
    s_nop 1
    v_mfma_f32_16x16x32_bf16 v[60:63], v[44:47], v[108:111], v[60:63]
    ds_read_b128 v[100:103], v8 offset:1280
    ds_read_b128 v[104:107], v8 offset:1296
    s_waitcnt lgkmcnt(0)
    v_cvt_pk_bf16_f32 v108, v100, v101
    v_cvt_pk_bf16_f32 v109, v102, v103
    v_cvt_pk_bf16_f32 v110, v104, v105
    v_cvt_pk_bf16_f32 v111, v106, v107
    s_nop 1
    v_mfma_f32_16x16x32_bf16 v[60:63], v[48:51], v[108:111], v[60:63]
    ds_read_b128 v[100:103], v8 offset:1408
    ds_read_b128 v[104:107], v8 offset:1424
    s_waitcnt lgkmcnt(0)
    v_cvt_pk_bf16_f32 v108, v100, v101
    v_cvt_pk_bf16_f32 v109, v102, v103
    v_cvt_pk_bf16_f32 v110, v104, v105
    v_cvt_pk_bf16_f32 v111, v106, v107
    s_nop 1
    v_mfma_f32_16x16x32_bf16 v[60:63], v[52:55], v[108:111], v[60:63]
    ds_read_b128 v[100:103], v8 offset:1536
    ds_read_b128 v[104:107], v8 offset:1552
    s_waitcnt lgkmcnt(0)
    v_cvt_pk_bf16_f32 v108, v100, v101
    v_cvt_pk_bf16_f32 v109, v102, v103
    v_cvt_pk_bf16_f32 v110, v104, v105
    v_cvt_pk_bf16_f32 v111, v106, v107
    s_nop 1
    v_mfma_f32_16x16x32_bf16 v[64:67], v[32:35], v[108:111], v[64:67]
    ds_read_b128 v[100:103], v8 offset:1664
    ds_read_b128 v[104:107], v8 offset:1680
    s_waitcnt lgkmcnt(0)
    v_cvt_pk_bf16_f32 v108, v100, v101
    v_cvt_pk_bf16_f32 v109, v102, v103
    v_cvt_pk_bf16_f32 v110, v104, v105
    v_cvt_pk_bf16_f32 v111, v106, v107
    s_nop 1
    v_mfma_f32_16x16x32_bf16 v[64:67], v[36:39], v[108:111], v[64:67]
    ds_read_b128 v[100:103], v8 offset:1792
    ds_read_b128 v[104:107], v8 offset:1808
    s_waitcnt lgkmcnt(0)
    v_cvt_pk_bf16_f32 v108, v100, v101
    v_cvt_pk_bf16_f32 v109, v102, v103
    v_cvt_pk_bf16_f32 v110, v104, v105
    v_cvt_pk_bf16_f32 v111, v106, v107
    s_nop 1
    v_mfma_f32_16x16x32_bf16 v[64:67], v[40:43], v[108:111], v[64:67]
    ds_read_b128 v[100:103], v8 offset:1920
    ds_read_b128 v[104:107], v8 offset:1936
    s_waitcnt lgkmcnt(0)
    v_cvt_pk_bf16_f32 v108, v100, v101
    v_cvt_pk_bf16_f32 v109, v102, v103
    v_cvt_pk_bf16_f32 v110, v104, v105
    v_cvt_pk_bf16_f32 v111, v106, v107
    s_nop 1
    v_mfma_f32_16x16x32_bf16 v[64:67], v[44:47], v[108:111], v[64:67]
    ds_read_b128 v[100:103], v8 offset:2048
    ds_read_b128 v[104:107], v8 offset:2064
    s_waitcnt lgkmcnt(0)
    v_cvt_pk_bf16_f32 v108, v100, v101
    v_cvt_pk_bf16_f32 v109, v102, v103
    v_cvt_pk_bf16_f32 v110, v104, v105
    v_cvt_pk_bf16_f32 v111, v106, v107
    s_nop 1
    v_mfma_f32_16x16x32_bf16 v[64:67], v[48:51], v[108:111], v[64:67]
    ds_read_b128 v[100:103], v8 offset:2176
    ds_read_b128 v[104:107], v8 offset:2192
    s_waitcnt lgkmcnt(0)
    v_cvt_pk_bf16_f32 v108, v100, v101
    v_cvt_pk_bf16_f32 v109, v102, v103
    v_cvt_pk_bf16_f32 v110, v104, v105
    v_cvt_pk_bf16_f32 v111, v106, v107
    s_nop 1
    v_mfma_f32_16x16x32_bf16 v[64:67], v[52:55], v[108:111], v[64:67]
    ds_read_b128 v[100:103], v8 offset:2304
    ds_read_b128 v[104:107], v8 offset:2320
    s_waitcnt lgkmcnt(0)
    v_cvt_pk_bf16_f32 v108, v100, v101
    v_cvt_pk_bf16_f32 v109, v102, v103
    v_cvt_pk_bf16_f32 v110, v104, v105
    v_cvt_pk_bf16_f32 v111, v106, v107
    s_nop 1
    v_mfma_f32_16x16x32_bf16 v[68:71], v[32:35], v[108:111], v[68:71]
    ds_read_b128 v[100:103], v8 offset:2432
    ds_read_b128 v[104:107], v8 offset:2448
    s_waitcnt lgkmcnt(0)
    v_cvt_pk_bf16_f32 v108, v100, v101
    v_cvt_pk_bf16_f32 v109, v102, v103
    v_cvt_pk_bf16_f32 v110, v104, v105
    v_cvt_pk_bf16_f32 v111, v106, v107
    s_nop 1
    v_mfma_f32_16x16x32_bf16 v[68:71], v[36:39], v[108:111], v[68:71]
    ds_read_b128 v[100:103], v8 offset:2560
    ds_read_b128 v[104:107], v8 offset:2576
    s_waitcnt lgkmcnt(0)
    v_cvt_pk_bf16_f32 v108, v100, v101
    v_cvt_pk_bf16_f32 v109, v102, v103
    v_cvt_pk_bf16_f32 v110, v104, v105
    v_cvt_pk_bf16_f32 v111, v106, v107
    s_nop 1
    v_mfma_f32_16x16x32_bf16 v[68:71], v[40:43], v[108:111], v[68:71]
    ds_read_b128 v[100:103], v8 offset:2688
    ds_read_b128 v[104:107], v8 offset:2704
    s_waitcnt lgkmcnt(0)
    v_cvt_pk_bf16_f32 v108, v100, v101
    v_cvt_pk_bf16_f32 v109, v102, v103
    v_cvt_pk_bf16_f32 v110, v104, v105
    v_cvt_pk_bf16_f32 v111, v106, v107
    s_nop 1
    v_mfma_f32_16x16x32_bf16 v[68:71], v[44:47], v[108:111], v[68:71]
    ds_read_b128 v[100:103], v8 offset:2816
    ds_read_b128 v[104:107], v8 offset:2832
    s_waitcnt lgkmcnt(0)
    v_cvt_pk_bf16_f32 v108, v100, v101
    v_cvt_pk_bf16_f32 v109, v102, v103
    v_cvt_pk_bf16_f32 v110, v104, v105
    v_cvt_pk_bf16_f32 v111, v106, v107
    s_nop 1
    v_mfma_f32_16x16x32_bf16 v[68:71], v[48:51], v[108:111], v[68:71]
    ds_read_b128 v[100:103], v8 offset:2944
    ds_read_b128 v[104:107], v8 offset:2960
    s_waitcnt lgkmcnt(0)
    v_cvt_pk_bf16_f32 v108, v100, v101
    v_cvt_pk_bf16_f32 v109, v102, v103
    v_cvt_pk_bf16_f32 v110, v104, v105
    v_cvt_pk_bf16_f32 v111, v106, v107
    s_nop 1
    v_mfma_f32_16x16x32_bf16 v[68:71], v[52:55], v[108:111], v[68:71]
    s_nop 7
    s_nop 3
    v_cmp_gt_u32 vcc, 20, v7
    s_and_saveexec_b64 s[30:31], vcc
    s_mov_b32 s47, 0xbfb8aa3b
    v_mul_f32 v112, s47, v56
    v_exp_f32 v112, v112
    s_nop 0
    v_add_f32 v112, 1.0, v112
    v_rcp_f32 v112, v112
    s_nop 0
    v_mul_f32 v113, s47, v57
    v_exp_f32 v113, v113
    s_nop 0
    v_add_f32 v113, 1.0, v113
    v_rcp_f32 v113, v113
    s_nop 0
    v_mul_f32 v114, s47, v58
    v_exp_f32 v114, v114
    s_nop 0
    v_add_f32 v114, 1.0, v114
    v_rcp_f32 v114, v114
    s_nop 0
    v_mul_f32 v115, s47, v59
    v_exp_f32 v115, v115
    s_nop 0
    v_add_f32 v115, 1.0, v115
    v_rcp_f32 v115, v115
    s_nop 0
    v_add_u32 v9, s46, v7
    v_lshlrev_b32 v9, 9, v9
    s_lshl_b32 s47, s44, 5
    v_add_u32 v9, s47, v9
    v_lshl_add_u32 v9, v2, 1, v9
    v_cvt_pk_bf16_f32 v116, v56, v57
    v_cvt_pk_bf16_f32 v117, v58, v59
    buffer_store_dwordx2 v[116:117], v9, s[16:19], 0 offen
    v_mul_f32 v60, v60, v112
    v_mul_f32 v61, v61, v113
    v_mul_f32 v62, v62, v114
    v_mul_f32 v63, v63, v115
    v_cvt_pk_bf16_f32 v118, v60, v61
    v_cvt_pk_bf16_f32 v119, v62, v63
    buffer_store_dwordx2 v[118:119], v9, s[16:19], 0 offen offset:128
    v_mul_f32 v64, v64, v112
    v_mul_f32 v65, v65, v113
    v_mul_f32 v66, v66, v114
    v_mul_f32 v67, v67, v115
    v_cvt_pk_bf16_f32 v120, v64, v65
    v_cvt_pk_bf16_f32 v121, v66, v67
    buffer_store_dwordx2 v[120:121], v9, s[16:19], 0 offen offset:256
    v_mul_f32 v68, v68, v112
    v_mul_f32 v69, v69, v113
    v_mul_f32 v70, v70, v114
    v_mul_f32 v71, v71, v115
    v_cvt_pk_bf16_f32 v122, v68, v69
    v_cvt_pk_bf16_f32 v123, v70, v71
    buffer_store_dwordx2 v[122:123], v9, s[16:19], 0 offen offset:384
    s_mov_b64 exec, s[30:31]
M_END:
    s_endpgm
.section .rodata,"a"
.p2align 6
.amdhsa_kernel tp_main_kernel
  .amdhsa_next_free_vgpr 256
  .amdhsa_next_free_sgpr 102
  .amdhsa_accum_offset 256
  .amdhsa_group_segment_fixed_size 0
  .amdhsa_kernarg_size 96
  .amdhsa_user_sgpr_count 2
  .amdhsa_user_sgpr_kernarg_segment_ptr 1
  .amdhsa_system_sgpr_workgroup_id_x 1
.end_amdhsa_kernel
.text
```
